```python
import torch

def _softmax(x, axis=-1):
    return torch.softmax(x, dim=axis)
def _gelu(x):
    return torch.nn.functional.gelu(x, approximate="tanh")
def _silu(x):
    return torch.nn.functional.silu(x)
def _sigmoid(x):
    return torch.sigmoid(x)
def _layernorm(x, axis=-1, eps=1e-5):
    m = x.mean(dim=axis, keepdim=True)
    v = x.var(dim=axis, keepdim=True, unbiased=False)
    return (x - m) / torch.sqrt(v + eps)
def _scatter_add(tgt, idx, src, axis=0):
    return tgt.clone().index_add_(axis, idx, src)
def _segment_sum(src, seg, n):
    out = torch.zeros((n,) + src.shape[1:], dtype=src.dtype)
    return out.index_add_(0, seg, src)
def _pad(x, pw):
    flat = tuple(v for pair in reversed(pw) for v in pair)
    return torch.nn.functional.pad(x, flat)

kernel_name = 'concat_heads__sliding_block_cached__mha_block_cached__decode'

def setup_inputs():

    _w = (lambda a: (lambda t: t.to(torch.bfloat16) if t.is_floating_point() else t)(torch.as_tensor(a)))
    def _A_setup():
        B, Sq, D = 2, 1, 512
        Hq, Hkv, Sk, Dh = 32, 8, 8192, 128
        assert Hq % Hkv == 0, (Hq, Hkv)
        return {
            "x": _w((lambda *s: torch.randn(*s, dtype=torch.bfloat16) * 0.8)(B, Sq, D)),
            "k_cache": _w((lambda *s: torch.randn(*s, dtype=torch.bfloat16) * 1.6)(B, Hkv, Sk, Dh)),
            "v_cache": _w((lambda *s: torch.randn(*s, dtype=torch.bfloat16) * 0.2)(B, Hkv, Sk, Dh)),
            "wq": _w((lambda *s: torch.randn(*s, dtype=torch.bfloat16) * 1.6)(D, Hq * Dh) * (D ** -0.5)),
            "wo": _w((lambda *s: torch.randn(*s, dtype=torch.bfloat16) * 0.2)(Hq * Dh, D) * ((Hq * Dh) ** -0.5)),
        }
    _A_in = _A_setup()

    def _B_setup():
        B, Sq, D = 2, 1, 512
        H, Sk, Dh = 32, 8192, 128
        return {
            "x": _w((lambda *s: torch.randn(*s, dtype=torch.bfloat16) * 0.8)(B, Sq, D)),
            "k_cache": _w((lambda *s: torch.randn(*s, dtype=torch.bfloat16) * 1.6)(B, H, Sk, Dh)),
            "v_cache": _w((lambda *s: torch.randn(*s, dtype=torch.bfloat16) * 0.2)(B, H, Sk, Dh)),
            "wq": _w((lambda *s: torch.randn(*s, dtype=torch.bfloat16) * 1.6)(D, H * Dh) * (D ** -0.5)),
            "wo": _w((lambda *s: torch.randn(*s, dtype=torch.bfloat16) * 0.2)(H * Dh, D) * ((H * Dh) ** -0.5)),
        }
    _B_in = _B_setup()

    return {
        "A_x": _A_in["x"],
        "A_k_cache": _A_in["k_cache"],
        "A_v_cache": _A_in["v_cache"],
        "A_wq": _A_in["wq"],
        "A_wo": _A_in["wo"],
        "B_x": _B_in["x"],
        "B_k_cache": _B_in["k_cache"],
        "B_v_cache": _B_in["v_cache"],
        "B_wq": _B_in["wq"],
        "B_wo": _B_in["wo"],
    }

def reference(A_x, A_k_cache, A_v_cache, A_wq, A_wo, B_x, B_k_cache, B_v_cache, B_wq, B_wo):
    def _A_ref(x, k_cache, v_cache, wq, wo):
        B, Sq, D = x.shape
        Hq, Dh = 32, 128
        Hkv, Sk = k_cache.shape[1], k_cache.shape[2]
        W = min(4096, max(256, Sk // 4))
        rep = Hq // Hkv
        q = (lambda x, *d: x.permute(*d))((x @ wq).reshape(B, Sq, Hq, Dh), 0, 2, 1, 3)
        k = (lambda x, n, axis: torch.repeat_interleave(x, n, dim=axis))(k_cache[:, :, Sk - W:, :], rep, axis=1)
        v = (lambda x, n, axis: torch.repeat_interleave(x, n, dim=axis))(v_cache[:, :, Sk - W:, :], rep, axis=1)
        scores = torch.einsum("bhqd,bhkd->bhqk", q, k) * (Dh ** -0.5)
        p = _softmax(scores, axis=-1)
        o = torch.einsum("bhqk,bhkd->bhqd", p, v)
        return (lambda x, *d: x.permute(*d))(o, 0, 2, 1, 3).reshape(B, Sq, Hq * Dh) @ wo

    def _B_ref(x, k_cache, v_cache, wq, wo):
        B, Sq, D = x.shape
        H, Dh = 32, 128
        q = (lambda x, *d: x.permute(*d))((x @ wq).reshape(B, Sq, H, Dh), 0, 2, 1, 3)
        scores = torch.einsum("bhqd,bhkd->bhqk", q, k_cache) * (Dh ** -0.5)
        p = _softmax(scores, axis=-1)
        o = torch.einsum("bhqk,bhkd->bhqd", p, v_cache)
        return (lambda x, *d: x.permute(*d))(o, 0, 2, 1, 3).reshape(B, Sq, H * Dh) @ wo

    a = _A_ref(A_x, A_k_cache, A_v_cache, A_wq, A_wo)
    b = _B_ref(B_x, B_k_cache, B_v_cache, B_wq, B_wo)
    return torch.concatenate([a, b], axis=-1)
```

```asm
; @launch grid=(256,1,1) block=(512,1,1) lds=16384
.amdgcn_target "amdgcn-amd-amdhsa--gfx950"
.text
.globl concat_heads__sliding_block_cached__mha_block_cached__decode_kernel
.p2align 12
.p2align 8
.type concat_heads__sliding_block_cached__mha_block_cached__decode_kernel,@function
concat_heads__sliding_block_cached__mha_block_cached__decode_kernel:
  s_cmp_ge_u32 s2, 256
  s_cbranch_scc1 L_end
  s_load_dwordx16 s[64:79], s[0:1], 0
  s_load_dwordx8 s[80:87], s[0:1], 64
  s_load_dwordx2 s[88:89], s[0:1], 96
  v_lshrrev_b32 v4, 6, v0
  v_and_b32 v1, 63, v0
  v_readfirstlane_b32 s3, v4
  s_and_b32 s5, s2, 7
  s_lshr_b32 s6, s2, 3
  s_lshr_b32 s7, s6, 3
  s_lshl_b32 s25, s5, 2
  s_add_u32 s96, s7, s25
  s_mov_b32 s97, s96
  s_bfe_u32 s8, s6, 0x10002
  s_and_b32 s9, s6, 3
  s_and_b32 s10, s6, 7
  s_and_b32 s4, s3, 3
  v_and_b32 v50, 15, v1
  v_lshrrev_b32 v51, 4, v1
  s_cmp_eq_u32 s3, 0
  s_cbranch_scc0 L_tc1
  s_call_b64 s[30:31], L_stub0
L_tc1:
  s_cmp_eq_u32 s3, 1
  s_cbranch_scc0 L_tc2
  s_call_b64 s[30:31], L_stub1
L_tc2:
  s_cmp_eq_u32 s3, 2
  s_cbranch_scc0 L_tc3
  s_call_b64 s[30:31], L_stub2
L_tc3:
  s_cmp_eq_u32 s3, 3
  s_cbranch_scc0 L_tc4
  s_call_b64 s[30:31], L_stub3
L_tc4:
  s_cmp_eq_u32 s3, 4
  s_cbranch_scc0 L_tc5
  s_call_b64 s[30:31], L_stub4
L_tc5:
  s_cmp_eq_u32 s3, 5
  s_cbranch_scc0 L_tc6
  s_call_b64 s[30:31], L_stub5
L_tc6:
  s_cmp_eq_u32 s3, 6
  s_cbranch_scc0 L_tc7
  s_call_b64 s[30:31], L_stub6
L_tc7:
  s_cmp_eq_u32 s3, 7
  s_cbranch_scc0 L_tc8
  s_call_b64 s[30:31], L_stub7
L_tc8:
  s_cmp_lt_u32 s3, 4
  s_cbranch_scc0 L_stream
  s_cmp_lt_u32 s4, 2
  s_cselect_b32 s7, s97, s96
  s_lshl_b32 s25, s10, 6
  v_add_lshl_u32 v4, s25, v1, 1
  v_lshlrev_b32 v2, 17, v51
  v_lshl_add_u32 v2, v50, 4, v2
  s_lshl_b32 s24, s10, 19
  s_lshl_b32 s25, s7, 8
  s_add_u32 s24, s24, s25
  s_mov_b32 s14, 0x400000
  s_mov_b32 s15, 0x00020000
  s_mov_b32 s22, 2048
  s_mov_b32 s23, 0x00020000
  v_lshlrev_b32 v52, 2, v50
  v_mov_b32 v53, 0
  ds_write_b32 v52, v53 offset:1280
  s_waitcnt lgkmcnt(0)
  s_cmp_lt_u32 s4, 2
  s_cselect_b32 s12, s80, s70
  s_cselect_b32 s13, s81, s71
  s_cselect_b32 s20, s74, s64
  s_cselect_b32 s21, s75, s65
  s_load_dwordx2 s[32:33], s[88:89], 0
  s_bitcmp0_b32 s4, 0
  s_cbranch_scc1 L_h_go
  s_barrier
  s_bitcmp1_b32 s4, 0
  s_cbranch_scc1 L_helper2
L_h_go:
  buffer_load_ushort v32, v4, s[20:23], 0 offen
  buffer_load_ushort v33, v4, s[20:23], 0 offen offset:1024
  buffer_load_dwordx4 v[64:67], v2, s[12:15], s24 offen nt
  s_add_u32 s24, s24, 0x2000
  buffer_load_dwordx4 v[96:99], v2, s[12:15], s24 offen nt
  s_add_u32 s24, s24, 0x2000
  buffer_load_dwordx4 v[68:71], v2, s[12:15], s24 offen nt
  s_add_u32 s24, s24, 0x2000
  buffer_load_dwordx4 v[100:103], v2, s[12:15], s24 offen nt
  s_add_u32 s24, s24, 0x2000
  buffer_load_dwordx4 v[72:75], v2, s[12:15], s24 offen nt
  s_add_u32 s24, s24, 0x2000
  buffer_load_dwordx4 v[104:107], v2, s[12:15], s24 offen nt
  s_add_u32 s24, s24, 0x2000
  buffer_load_dwordx4 v[76:79], v2, s[12:15], s24 offen nt
  s_add_u32 s24, s24, 0x2000
  buffer_load_dwordx4 v[108:111], v2, s[12:15], s24 offen nt
  s_add_u32 s24, s24, 0x2000
  buffer_load_dwordx4 v[80:83], v2, s[12:15], s24 offen nt
  s_add_u32 s24, s24, 0x2000
  buffer_load_dwordx4 v[112:115], v2, s[12:15], s24 offen nt
  s_add_u32 s24, s24, 0x2000
  buffer_load_dwordx4 v[84:87], v2, s[12:15], s24 offen nt
  s_add_u32 s24, s24, 0x2000
  buffer_load_dwordx4 v[116:119], v2, s[12:15], s24 offen nt
  s_add_u32 s24, s24, 0x2000
  buffer_load_dwordx4 v[88:91], v2, s[12:15], s24 offen nt
  s_add_u32 s24, s24, 0x2000
  buffer_load_dwordx4 v[120:123], v2, s[12:15], s24 offen nt
  s_add_u32 s24, s24, 0x2000
  buffer_load_dwordx4 v[92:95], v2, s[12:15], s24 offen nt
  s_add_u32 s24, s24, 0x2000
  buffer_load_dwordx4 v[124:127], v2, s[12:15], s24 offen nt
  s_barrier
  s_branch L_helper2
L_stream:
  s_lshl_b32 s25, s4, 11
  v_lshlrev_b32 v208, 4, v1
  v_add_u32 v208, s25, v208
  v_add_u32 v209, 8192, v208
  v_add_u32 v210, 16384, v208
  v_add_u32 v211, 24576, v208
  s_mov_b32 s7, s97
  s_lshl_b32 s45, s8, 5
  s_add_u32 s45, s45, s7
  s_lshl_b32 s45, s45, 2
  s_add_u32 s45, s45, s9
  s_lshl_b32 s45, s45, 19
  s_lshr_b32 s25, s6, 1
  s_xor_b32 s25, s25, s6
  s_and_b32 s25, s25, 1
  s_lshl_b32 s93, s25, 17
  s_mov_b32 s25, s8
  s_lshl_b32 s25, s25, 18
  s_or_b32 s93, s93, s25
  s_mov_b32 s92, 0
  s_mov_b32 s24, s93
  s_mov_b32 s14, 0x80000
  s_mov_b32 s15, 0x00020000
  s_waitcnt lgkmcnt(0)
  s_add_u32 s12, s76, s45
  s_addc_u32 s13, s77, 0
  s_load_dwordx2 s[32:33], s[88:89], 0
  s_waitcnt vmcnt(4)
  buffer_load_dwordx4 v[64:67], v208, s[12:15], s24 offen offset:0 nt
  s_waitcnt vmcnt(4)
  buffer_load_dwordx4 v[68:71], v208, s[12:15], s24 offen offset:1024 nt
  s_waitcnt vmcnt(4)
  buffer_load_dwordx4 v[72:75], v209, s[12:15], s24 offen offset:0 nt
  s_barrier
  s_waitcnt vmcnt(4)
  buffer_load_dwordx4 v[76:79], v209, s[12:15], s24 offen offset:1024 nt
  s_waitcnt vmcnt(4)
  buffer_load_dwordx4 v[80:83], v210, s[12:15], s24 offen offset:0 nt
  s_waitcnt vmcnt(4)
  buffer_load_dwordx4 v[84:87], v210, s[12:15], s24 offen offset:1024 nt
  s_waitcnt vmcnt(4)
  buffer_load_dwordx4 v[88:91], v211, s[12:15], s24 offen offset:0 nt
  s_waitcnt vmcnt(5)
  buffer_load_dwordx4 v[92:95], v211, s[12:15], s24 offen offset:1024 nt
  s_add_u32 s92, s92, 0x8000
  s_and_b32 s92, s92, 0x7ffff
  s_xor_b32 s24, s92, s93
  s_call_b64 s[30:31], L_ISSK1
  s_call_b64 s[30:31], L_ISSK2
  s_call_b64 s[30:31], L_ISSK3
  s_mov_b32 s34, 0xcccccccc
  s_mov_b32 s35, 0xcccccccc
  s_mov_b32 s36, 0xaaaaaaaa
  s_mov_b32 s37, 0xaaaaaaaa
  s_mov_b32 s38, 0x3db504f3
  s_mov_b32 s39, 0x3fb8aa3b
  s_mov_b32 s40, 0xffff0000
  s_mov_b32 s16, s88
  s_mov_b32 s17, s89
  s_mov_b32 s18, 536870912
  s_mov_b32 s19, 0x00020000
  s_waitcnt lgkmcnt(0)
  s_add_u32 s32, s32, 1
  s_xor_b32 s28, s32, 0x5bd1e995
  s_mul_i32 s29, s32, 0x9e3779b1
  s_add_u32 s29, s29, s33
  v_mov_b32 v52, 1296
  s_mov_b32 s41, 2097152
L_s_qwait:
  ds_read_b32 v53, v52
  s_waitcnt lgkmcnt(0)
  v_readfirstlane_b32 s25, v53
  s_branch L_skip0
L_stub0:
  s_setpc_b64 s[30:31]
L_skip0:
  s_nop 0
  s_cmp_ge_u32 s25, 1
  s_cbranch_scc1 L_s_qwait_ok
  s_sleep 1
  s_sub_u32 s41, s41, 1
  s_cbranch_scc0 L_s_qwait
L_s_qwait_ok:
  v_lshlrev_b32 v4, 4, v50
  ds_read_b128 v[8:11], v4 offset:0
  s_waitcnt lgkmcnt(0)
  s_call_b64 s[30:31], L_KB0
  s_call_b64 s[30:31], L_ISSK0
  s_call_b64 s[30:31], L_KB1
  s_call_b64 s[30:31], L_ISSK1
  s_call_b64 s[30:31], L_KB2
  s_call_b64 s[30:31], L_ISSK2
  s_call_b64 s[30:31], L_KB3
  s_call_b64 s[30:31], L_ISSK3
  v_mov_b32 v36, v28
  v_mov_b32 v37, v29
  s_call_b64 s[30:31], L_KB0
  s_call_b64 s[30:31], L_ISSK0
  s_call_b64 s[30:31], L_KB1
  s_call_b64 s[30:31], L_ISSK1
  s_call_b64 s[30:31], L_KB2
  s_call_b64 s[30:31], L_ISSK2
  s_call_b64 s[30:31], L_KB3
  s_call_b64 s[30:31], L_ISSK3
  v_mov_b32 v38, v28
  v_mov_b32 v39, v29
  s_call_b64 s[30:31], L_KB0
  s_call_b64 s[30:31], L_ISSK0
  s_call_b64 s[30:31], L_KB1
  s_call_b64 s[30:31], L_ISSK1
  s_call_b64 s[30:31], L_KB2
  s_call_b64 s[30:31], L_ISSK2
  s_call_b64 s[30:31], L_KB3
  s_call_b64 s[30:31], L_ISSK3
  v_mov_b32 v40, v28
  v_mov_b32 v41, v29
  s_add_u32 s12, s78, s45
  s_addc_u32 s13, s79, 0
  s_call_b64 s[30:31], L_KB0
  s_call_b64 s[30:31], L_ISSK0
  s_call_b64 s[30:31], L_KB1
  s_waitcnt vmcnt(16)
  s_call_b64 s[30:31], L_KB2
  s_call_b64 s[30:31], L_ISSK1
  s_waitcnt vmcnt(16)
  s_call_b64 s[30:31], L_KB3
  v_mov_b32 v42, v28
  v_mov_b32 v43, v29
  v_cvt_pk_bf16_f32 v4, v36, v37
  v_lshlrev_b32 v36, 16, v4
  v_and_b32 v37, s40, v4
  v_mul_f32 v36, s38, v36
  v_mul_f32 v37, s38, v37
  v_cvt_pk_bf16_f32 v4, v36, v37
  v_lshlrev_b32 v36, 16, v4
  v_and_b32 v37, s40, v4
  v_cvt_pk_bf16_f32 v4, v38, v39
  v_lshlrev_b32 v38, 16, v4
  v_and_b32 v39, s40, v4
  v_mul_f32 v38, s38, v38
  v_mul_f32 v39, s38, v39
  v_cvt_pk_bf16_f32 v4, v38, v39
  v_lshlrev_b32 v38, 16, v4
  v_and_b32 v39, s40, v4
  v_cvt_pk_bf16_f32 v4, v40, v41
  v_lshlrev_b32 v40, 16, v4
  v_and_b32 v41, s40, v4
  v_mul_f32 v40, s38, v40
  v_mul_f32 v41, s38, v41
  v_cvt_pk_bf16_f32 v4, v40, v41
  v_lshlrev_b32 v40, 16, v4
  v_and_b32 v41, s40, v4
  v_cvt_pk_bf16_f32 v4, v42, v43
  v_lshlrev_b32 v42, 16, v4
  v_and_b32 v43, s40, v4
  v_mul_f32 v42, s38, v42
  v_mul_f32 v43, s38, v43
  v_cvt_pk_bf16_f32 v4, v42, v43
  v_lshlrev_b32 v42, 16, v4
  v_and_b32 v43, s40, v4
  v_max3_f32 v48, v36, v37, v38
  v_max3_f32 v48, v48, v39, v40
  v_max3_f32 v48, v48, v41, v42
  v_max_f32 v48, v48, v43
  s_nop 1
  v_max_f32_dpp v48, v48, v48 row_mirror row_mask:0xf bank_mask:0xf
  s_nop 1
  v_max_f32_dpp v48, v48, v48 row_half_mirror row_mask:0xf bank_mask:0xf
  s_nop 1
  v_max_f32_dpp v48, v48, v48 quad_perm:[2,3,0,1] row_mask:0xf bank_mask:0xf
  s_nop 1
  v_max_f32_dpp v48, v48, v48 quad_perm:[1,0,3,2] row_mask:0xf bank_mask:0xf
  v_mov_b32 v4, v48
  s_nop 1
  v_permlane16_swap_b32 v48, v4
  v_max_f32 v48, v48, v4
  v_mov_b32 v4, v48
  s_nop 1
  v_permlane32_swap_b32 v48, v4
  v_max_f32 v48, v48, v4
  s_call_b64 s[30:31], L_ISSK2
  v_sub_f32 v36, v36, v48
  v_sub_f32 v37, v37, v48
  v_sub_f32 v38, v38, v48
  v_sub_f32 v39, v39, v48
  v_sub_f32 v40, v40, v48
  v_sub_f32 v41, v41, v48
  v_sub_f32 v42, v42, v48
  v_sub_f32 v43, v43, v48
  v_mul_f32 v36, s39, v36
  v_mul_f32 v37, s39, v37
  v_mul_f32 v38, s39, v38
  v_mul_f32 v39, s39, v39
  v_mul_f32 v40, s39, v40
  v_mul_f32 v41, s39, v41
  v_mul_f32 v42, s39, v42
  v_mul_f32 v43, s39, v43
  v_exp_f32 v36, v36
  v_exp_f32 v37, v37
  v_exp_f32 v38, v38
  v_exp_f32 v39, v39
  v_exp_f32 v40, v40
  v_exp_f32 v41, v41
  v_exp_f32 v42, v42
  v_exp_f32 v43, v43
  v_add_f32 v49, v36, v37
  v_add_f32 v49, v49, v38
  v_add_f32 v49, v49, v39
  v_add_f32 v49, v49, v40
  v_add_f32 v49, v49, v41
  v_add_f32 v49, v49, v42
  v_add_f32 v49, v49, v43
  s_nop 1
  v_add_f32_dpp v49, v49, v49 row_mirror row_mask:0xf bank_mask:0xf
  s_nop 1
  v_add_f32_dpp v49, v49, v49 row_half_mirror row_mask:0xf bank_mask:0xf
  s_nop 1
  v_add_f32_dpp v49, v49, v49 quad_perm:[2,3,0,1] row_mask:0xf bank_mask:0xf
  s_nop 1
  v_add_f32_dpp v49, v49, v49 quad_perm:[1,0,3,2] row_mask:0xf bank_mask:0xf
  v_mov_b32 v4, v49
  s_nop 1
  v_permlane16_swap_b32 v49, v4
  v_add_f32 v49, v49, v4
  v_mov_b32 v4, v49
  s_nop 1
  v_permlane32_swap_b32 v49, v4
  v_add_f32 v49, v49, v4
  v_rcp_f32 v4, v49
  s_nop 0
  v_mul_f32 v36, v36, v4
  v_mul_f32 v37, v37, v4
  v_mul_f32 v38, v38, v4
  v_mul_f32 v39, v39, v4
  v_mul_f32 v40, v40, v4
  v_mul_f32 v41, v41, v4
  v_mul_f32 v42, v42, v4
  v_mul_f32 v43, v43, v4
  v_cvt_pk_bf16_f32 v36, v36, 0
  v_cvt_pk_bf16_f32 v37, v37, 0
  v_cvt_pk_bf16_f32 v38, v38, 0
  v_cvt_pk_bf16_f32 v39, v39, 0
  v_cvt_pk_bf16_f32 v40, v40, 0
  v_cvt_pk_bf16_f32 v41, v41, 0
  v_cvt_pk_bf16_f32 v42, v42, 0
  v_cvt_pk_bf16_f32 v43, v43, 0
  s_add_u32 s44, s7, 32
  s_lshl_b32 s44, s44, 1
  s_add_u32 s44, s44, s8
  s_lshl_b32 s44, s44, 2
  s_add_u32 s44, s44, s9
  s_lshl_b32 s90, s44, 11
  s_add_u32 s90, s90, 3145728
  s_lshl_b32 s44, s44, 2
  s_add_u32 s44, s44, s4
  s_mul_i32 s44, s44, 640
  s_add_u32 s44, s44, 2097152
  s_mov_b32 s91, 6
  s_call_b64 s[30:31], L_PUBML
  s_call_b64 s[30:31], L_ISSK3
  v_mov_b32 v12, 0
  v_mov_b32 v13, 0
  v_mov_b32 v14, 0
  v_mov_b32 v15, 0
  v_mov_b32 v16, 0
  v_mov_b32 v17, 0
  v_mov_b32 v18, 0
  v_mov_b32 v19, 0
  s_lshl_b32 s25, s4, 4
  s_add_u32 s90, s90, s25
  v_lshrrev_b32 v55, 1, v51
  v_lshlrev_b32 v55, 4, v55
  v_add_lshl_u32 v55, v55, v50, 6
  v_mov_b32 v32, v36
  s_waitcnt vmcnt(24)
  s_call_b64 s[30:31], L_WS0
  s_waitcnt vmcnt(16)
  s_call_b64 s[30:31], L_WS1
  s_call_b64 s[30:31], L_ISSK0
  v_mov_b32 v33, v37
  s_waitcnt vmcnt(16)
  s_call_b64 s[30:31], L_WS2
  s_waitcnt vmcnt(8)
  s_call_b64 s[30:31], L_WS3
  s_call_b64 s[30:31], L_ISSK1
  v_mov_b32 v32, v38
  s_waitcnt vmcnt(8)
  s_call_b64 s[30:31], L_WS0
  s_call_b64 s[30:31], L_ISSK2
  s_barrier
  s_waitcnt vmcnt(8)
  s_call_b64 s[30:31], L_WS1
  s_call_b64 s[30:31], L_ISSK3
  v_mov_b32 v33, v39
  s_waitcnt vmcnt(8)
  s_call_b64 s[30:31], L_WS2
  s_call_b64 s[30:31], L_ISSK0
  s_waitcnt vmcnt(8)
  s_call_b64 s[30:31], L_WS3
  s_branch L_skip1
L_stub1:
  s_setpc_b64 s[30:31]
L_skip1:
  s_call_b64 s[30:31], L_ISSK1
  v_mov_b32 v52, 1300
  ds_read_b32 v53, v52
  s_waitcnt lgkmcnt(0)
  v_readfirstlane_b32 s43, v53
  s_nop 0
  s_cmp_eq_u32 s43, 0
  s_cselect_b32 s43, 19, s43
  s_cmp_ge_u32 s43, 22
  s_cbranch_scc1 L_s_v6
  s_call_b64 s[30:31], L_ISSK2
  s_branch L_s_w6
L_s_v6:
  s_call_b64 s[30:31], L_ISSV2
L_s_w6:
  v_mov_b32 v32, v40
  s_waitcnt vmcnt(16)
  s_call_b64 s[30:31], L_WS0
  s_cmp_ge_u32 s43, 21
  s_cbranch_scc1 L_s_v5
  s_call_b64 s[30:31], L_ISSK3
  s_branch L_s_w5
L_s_v5:
  s_call_b64 s[30:31], L_ISSV3
L_s_w5:
  s_waitcnt vmcnt(16)
  s_call_b64 s[30:31], L_WS1
  s_cmp_ge_u32 s43, 20
  s_cbranch_scc1 L_s_v4
  s_call_b64 s[30:31], L_ISSK0
  s_branch L_s_w4
L_s_v4:
  s_call_b64 s[30:31], L_ISSV0
L_s_w4:
  v_mov_b32 v33, v41
  s_waitcnt vmcnt(16)
  s_call_b64 s[30:31], L_WS2
  s_cmp_ge_u32 s43, 19
  s_cbranch_scc1 L_s_v3
  s_call_b64 s[30:31], L_ISSK1
  s_branch L_s_w3
L_s_v3:
  s_call_b64 s[30:31], L_ISSV1
L_s_w3:
  s_waitcnt vmcnt(16)
  s_call_b64 s[30:31], L_WS3
  s_cmp_ge_u32 s43, 18
  s_cbranch_scc1 L_s_v2
  s_call_b64 s[30:31], L_ISSK2
  s_branch L_s_w2
L_s_v2:
  s_call_b64 s[30:31], L_ISSV2
L_s_w2:
  v_mov_b32 v52, 1304
  v_mov_b32 v53, 1
  ds_write_b32 v52, v53
  v_mov_b32 v32, v42
  s_waitcnt vmcnt(16)
  s_call_b64 s[30:31], L_WS0
  s_cmp_ge_u32 s43, 17
  s_cbranch_scc1 L_s_v1
  s_call_b64 s[30:31], L_ISSK3
  s_branch L_s_w1
L_s_v1:
  s_call_b64 s[30:31], L_ISSV3
L_s_w1:
  s_waitcnt vmcnt(16)
  s_call_b64 s[30:31], L_WS1
  v_mov_b32 v33, v43
  s_waitcnt vmcnt(8)
  s_call_b64 s[30:31], L_WS2
  s_call_b64 s[30:31], L_WS3L
  v_permlane32_swap_b32 v12, v16
  v_permlane32_swap_b32 v13, v17
  v_permlane32_swap_b32 v14, v18
  v_permlane32_swap_b32 v15, v19
  v_add_f32 v12, v12, v16
  v_add_f32 v13, v13, v17
  v_add_f32 v14, v14, v18
  v_add_f32 v15, v15, v19
  s_nop 0
  v_permlane16_swap_b32 v12, v14
  v_permlane16_swap_b32 v13, v15
  v_add_f32 v12, v12, v14
  v_add_f32 v13, v13, v15
  v_cvt_pk_bf16_f32 v44, v12, v13
  v_cvt_pk_bf16_f32 v46, v12, v13
  s_nop 1
  v_permlane16_swap_b32 v44, v46
  s_mov_b32 exec_lo, 0xffff
  s_mov_b32 exec_hi, 0xffff
  buffer_store_dwordx4 v[44:47], v55, s[16:19], s90 offen
  s_mov_b64 exec, -1
  s_barrier
  s_branch L_exit
L_ISSK0:
  s_waitcnt vmcnt(4)
  buffer_load_dwordx4 v[64:67], v208, s[12:15], s24 offen offset:0 nt
  s_waitcnt vmcnt(4)
  buffer_load_dwordx4 v[68:71], v208, s[12:15], s24 offen offset:1024 nt
  s_waitcnt vmcnt(4)
  buffer_load_dwordx4 v[72:75], v209, s[12:15], s24 offen offset:0 nt
  s_waitcnt vmcnt(4)
  buffer_load_dwordx4 v[76:79], v209, s[12:15], s24 offen offset:1024 nt
  s_waitcnt vmcnt(4)
  buffer_load_dwordx4 v[80:83], v210, s[12:15], s24 offen offset:0 nt
  s_waitcnt vmcnt(4)
  buffer_load_dwordx4 v[84:87], v210, s[12:15], s24 offen offset:1024 nt
  s_waitcnt vmcnt(4)
  buffer_load_dwordx4 v[88:91], v211, s[12:15], s24 offen offset:0 nt
  s_waitcnt vmcnt(5)
  buffer_load_dwordx4 v[92:95], v211, s[12:15], s24 offen offset:1024 nt
  s_add_u32 s92, s92, 0x8000
  s_and_b32 s92, s92, 0x7ffff
  s_xor_b32 s24, s92, s93
  s_setpc_b64 s[30:31]
L_ISSK1:
  s_waitcnt vmcnt(4)
  buffer_load_dwordx4 v[96:99], v208, s[12:15], s24 offen offset:0 nt
  s_waitcnt vmcnt(4)
  buffer_load_dwordx4 v[100:103], v208, s[12:15], s24 offen offset:1024 nt
  s_waitcnt vmcnt(4)
  buffer_load_dwordx4 v[104:107], v209, s[12:15], s24 offen offset:0 nt
  s_waitcnt vmcnt(4)
  buffer_load_dwordx4 v[108:111], v209, s[12:15], s24 offen offset:1024 nt
  s_waitcnt vmcnt(4)
  buffer_load_dwordx4 v[112:115], v210, s[12:15], s24 offen offset:0 nt
  s_waitcnt vmcnt(4)
  buffer_load_dwordx4 v[116:119], v210, s[12:15], s24 offen offset:1024 nt
  s_waitcnt vmcnt(4)
  buffer_load_dwordx4 v[120:123], v211, s[12:15], s24 offen offset:0 nt
  s_waitcnt vmcnt(5)
  buffer_load_dwordx4 v[124:127], v211, s[12:15], s24 offen offset:1024 nt
  s_add_u32 s92, s92, 0x8000
  s_and_b32 s92, s92, 0x7ffff
  s_xor_b32 s24, s92, s93
  s_setpc_b64 s[30:31]
L_ISSK2:
  s_waitcnt vmcnt(4)
  buffer_load_dwordx4 v[128:131], v208, s[12:15], s24 offen offset:0 nt
  s_waitcnt vmcnt(4)
  buffer_load_dwordx4 v[132:135], v208, s[12:15], s24 offen offset:1024 nt
  s_waitcnt vmcnt(4)
  buffer_load_dwordx4 v[136:139], v209, s[12:15], s24 offen offset:0 nt
  s_waitcnt vmcnt(4)
  buffer_load_dwordx4 v[140:143], v209, s[12:15], s24 offen offset:1024 nt
  s_waitcnt vmcnt(4)
  buffer_load_dwordx4 v[144:147], v210, s[12:15], s24 offen offset:0 nt
  s_waitcnt vmcnt(4)
  buffer_load_dwordx4 v[148:151], v210, s[12:15], s24 offen offset:1024 nt
  s_waitcnt vmcnt(4)
  buffer_load_dwordx4 v[152:155], v211, s[12:15], s24 offen offset:0 nt
  s_waitcnt vmcnt(5)
  buffer_load_dwordx4 v[156:159], v211, s[12:15], s24 offen offset:1024 nt
  s_add_u32 s92, s92, 0x8000
  s_and_b32 s92, s92, 0x7ffff
  s_xor_b32 s24, s92, s93
  s_setpc_b64 s[30:31]
L_ISSK3:
  s_waitcnt vmcnt(4)
  buffer_load_dwordx4 v[160:163], v208, s[12:15], s24 offen offset:0 nt
  s_waitcnt vmcnt(4)
  buffer_load_dwordx4 v[164:167], v208, s[12:15], s24 offen offset:1024 nt
  s_waitcnt vmcnt(4)
  buffer_load_dwordx4 v[168:171], v209, s[12:15], s24 offen offset:0 nt
  s_waitcnt vmcnt(4)
  buffer_load_dwordx4 v[172:175], v209, s[12:15], s24 offen offset:1024 nt
  s_waitcnt vmcnt(4)
  buffer_load_dwordx4 v[176:179], v210, s[12:15], s24 offen offset:0 nt
  s_waitcnt vmcnt(4)
  buffer_load_dwordx4 v[180:183], v210, s[12:15], s24 offen offset:1024 nt
  s_waitcnt vmcnt(4)
  buffer_load_dwordx4 v[184:187], v211, s[12:15], s24 offen offset:0 nt
  s_waitcnt vmcnt(5)
  buffer_load_dwordx4 v[188:191], v211, s[12:15], s24 offen offset:1024 nt
  s_add_u32 s92, s92, 0x8000
  s_and_b32 s92, s92, 0x7ffff
  s_xor_b32 s24, s92, s93
  s_setpc_b64 s[30:31]
L_ISSV0:
  s_waitcnt vmcnt(15)
  buffer_load_dwordx4 v[64:67], v208, s[12:15], s24 offen offset:0 nt
  s_waitcnt vmcnt(15)
  buffer_load_dwordx4 v[68:71], v208, s[12:15], s24 offen offset:1024 nt
  s_waitcnt vmcnt(15)
  buffer_load_dwordx4 v[72:75], v209, s[12:15], s24 offen offset:0 nt
  s_waitcnt vmcnt(15)
  buffer_load_dwordx4 v[76:79], v209, s[12:15], s24 offen offset:1024 nt
  s_waitcnt vmcnt(15)
  buffer_load_dwordx4 v[80:83], v210, s[12:15], s24 offen offset:0 nt
  s_waitcnt vmcnt(15)
  buffer_load_dwordx4 v[84:87], v210, s[12:15], s24 offen offset:1024 nt
  s_waitcnt vmcnt(15)
  buffer_load_dwordx4 v[88:91], v211, s[12:15], s24 offen offset:0 nt
  s_waitcnt vmcnt(15)
  buffer_load_dwordx4 v[92:95], v211, s[12:15], s24 offen offset:1024 nt
  s_add_u32 s92, s92, 0x8000
  s_and_b32 s92, s92, 0x7ffff
  s_xor_b32 s24, s92, s93
  s_setpc_b64 s[30:31]
L_ISSV1:
  s_waitcnt vmcnt(15)
  buffer_load_dwordx4 v[96:99], v208, s[12:15], s24 offen offset:0 nt
  s_waitcnt vmcnt(15)
  buffer_load_dwordx4 v[100:103], v208, s[12:15], s24 offen offset:1024 nt
  s_waitcnt vmcnt(15)
  buffer_load_dwordx4 v[104:107], v209, s[12:15], s24 offen offset:0 nt
  s_waitcnt vmcnt(15)
  buffer_load_dwordx4 v[108:111], v209, s[12:15], s24 offen offset:1024 nt
  s_branch L_skip2
L_stub2:
  s_setpc_b64 s[30:31]
L_skip2:
  s_waitcnt vmcnt(15)
  buffer_load_dwordx4 v[112:115], v210, s[12:15], s24 offen offset:0 nt
  s_waitcnt vmcnt(15)
  buffer_load_dwordx4 v[116:119], v210, s[12:15], s24 offen offset:1024 nt
  s_waitcnt vmcnt(15)
  buffer_load_dwordx4 v[120:123], v211, s[12:15], s24 offen offset:0 nt
  s_waitcnt vmcnt(15)
  buffer_load_dwordx4 v[124:127], v211, s[12:15], s24 offen offset:1024 nt
  s_add_u32 s92, s92, 0x8000
  s_and_b32 s92, s92, 0x7ffff
  s_xor_b32 s24, s92, s93
  s_setpc_b64 s[30:31]
L_ISSV2:
  s_waitcnt vmcnt(15)
  buffer_load_dwordx4 v[128:131], v208, s[12:15], s24 offen offset:0 nt
  s_waitcnt vmcnt(15)
  buffer_load_dwordx4 v[132:135], v208, s[12:15], s24 offen offset:1024 nt
  s_waitcnt vmcnt(15)
  buffer_load_dwordx4 v[136:139], v209, s[12:15], s24 offen offset:0 nt
  s_waitcnt vmcnt(15)
  buffer_load_dwordx4 v[140:143], v209, s[12:15], s24 offen offset:1024 nt
  s_waitcnt vmcnt(15)
  buffer_load_dwordx4 v[144:147], v210, s[12:15], s24 offen offset:0 nt
  s_waitcnt vmcnt(15)
  buffer_load_dwordx4 v[148:151], v210, s[12:15], s24 offen offset:1024 nt
  s_waitcnt vmcnt(15)
  buffer_load_dwordx4 v[152:155], v211, s[12:15], s24 offen offset:0 nt
  s_waitcnt vmcnt(15)
  buffer_load_dwordx4 v[156:159], v211, s[12:15], s24 offen offset:1024 nt
  s_add_u32 s92, s92, 0x8000
  s_and_b32 s92, s92, 0x7ffff
  s_xor_b32 s24, s92, s93
  s_setpc_b64 s[30:31]
L_ISSV3:
  s_waitcnt vmcnt(15)
  buffer_load_dwordx4 v[160:163], v208, s[12:15], s24 offen offset:0 nt
  s_waitcnt vmcnt(15)
  buffer_load_dwordx4 v[164:167], v208, s[12:15], s24 offen offset:1024 nt
  s_waitcnt vmcnt(15)
  buffer_load_dwordx4 v[168:171], v209, s[12:15], s24 offen offset:0 nt
  s_waitcnt vmcnt(15)
  buffer_load_dwordx4 v[172:175], v209, s[12:15], s24 offen offset:1024 nt
  s_waitcnt vmcnt(15)
  buffer_load_dwordx4 v[176:179], v210, s[12:15], s24 offen offset:0 nt
  s_waitcnt vmcnt(15)
  buffer_load_dwordx4 v[180:183], v210, s[12:15], s24 offen offset:1024 nt
  s_waitcnt vmcnt(15)
  buffer_load_dwordx4 v[184:187], v211, s[12:15], s24 offen offset:0 nt
  s_waitcnt vmcnt(15)
  buffer_load_dwordx4 v[188:191], v211, s[12:15], s24 offen offset:1024 nt
  s_add_u32 s92, s92, 0x8000
  s_and_b32 s92, s92, 0x7ffff
  s_xor_b32 s24, s92, s93
  s_setpc_b64 s[30:31]
L_KB0:
  v_mov_b32 v20, 0
  v_mov_b32 v21, 0
  v_mov_b32 v22, 0
  v_mov_b32 v23, 0
  v_mov_b32 v24, 0
  v_mov_b32 v25, 0
  v_mov_b32 v26, 0
  v_mov_b32 v27, 0
  v_dot2c_f32_bf16 v20, v64, v8
  v_dot2c_f32_bf16 v21, v68, v8
  v_dot2c_f32_bf16 v22, v72, v8
  v_dot2c_f32_bf16 v23, v76, v8
  v_dot2c_f32_bf16 v24, v80, v8
  v_dot2c_f32_bf16 v25, v84, v8
  v_dot2c_f32_bf16 v26, v88, v8
  v_dot2c_f32_bf16 v27, v92, v8
  v_dot2c_f32_bf16 v20, v65, v9
  v_dot2c_f32_bf16 v21, v69, v9
  v_dot2c_f32_bf16 v22, v73, v9
  v_dot2c_f32_bf16 v23, v77, v9
  v_dot2c_f32_bf16 v24, v81, v9
  v_dot2c_f32_bf16 v25, v85, v9
  v_dot2c_f32_bf16 v26, v89, v9
  v_dot2c_f32_bf16 v27, v93, v9
  v_dot2c_f32_bf16 v20, v66, v10
  v_dot2c_f32_bf16 v21, v70, v10
  v_dot2c_f32_bf16 v22, v74, v10
  v_dot2c_f32_bf16 v23, v78, v10
  v_dot2c_f32_bf16 v24, v82, v10
  v_dot2c_f32_bf16 v25, v86, v10
  v_dot2c_f32_bf16 v26, v90, v10
  v_dot2c_f32_bf16 v27, v94, v10
  v_dot2c_f32_bf16 v20, v67, v11
  v_dot2c_f32_bf16 v21, v71, v11
  v_dot2c_f32_bf16 v22, v75, v11
  v_dot2c_f32_bf16 v23, v79, v11
  v_dot2c_f32_bf16 v24, v83, v11
  v_dot2c_f32_bf16 v25, v87, v11
  v_dot2c_f32_bf16 v26, v91, v11
  v_dot2c_f32_bf16 v27, v95, v11
  v_add_f32_dpp v20, v20, v20 row_mirror row_mask:0xf bank_mask:0x3
  v_add_f32_dpp v21, v21, v21 row_mirror row_mask:0xf bank_mask:0x3
  v_add_f32_dpp v22, v22, v22 row_mirror row_mask:0xf bank_mask:0x3
  v_add_f32_dpp v23, v23, v23 row_mirror row_mask:0xf bank_mask:0x3
  v_add_f32_dpp v20, v24, v24 row_mirror row_mask:0xf bank_mask:0xc
  v_add_f32_dpp v21, v25, v25 row_mirror row_mask:0xf bank_mask:0xc
  v_add_f32_dpp v22, v26, v26 row_mirror row_mask:0xf bank_mask:0xc
  v_add_f32_dpp v23, v27, v27 row_mirror row_mask:0xf bank_mask:0xc
  v_add_f32_dpp v20, v20, v20 row_half_mirror row_mask:0xf bank_mask:0x5
  v_add_f32_dpp v21, v21, v21 row_half_mirror row_mask:0xf bank_mask:0x5
  s_nop 0
  v_add_f32_dpp v20, v22, v22 row_half_mirror row_mask:0xf bank_mask:0xa
  v_add_f32_dpp v21, v23, v23 row_half_mirror row_mask:0xf bank_mask:0xa
  s_nop 0
  v_add_f32_dpp v20, v20, v20 quad_perm:[2,3,0,1] row_mask:0xf bank_mask:0xf
  v_add_f32_dpp v21, v21, v21 quad_perm:[2,3,0,1] row_mask:0xf bank_mask:0xf
  v_cndmask_b32 v20, v20, v21, s[34:35]
  s_nop 1
  v_add_f32_dpp v30, v20, v20 quad_perm:[1,0,3,2] row_mask:0xf bank_mask:0xf
  s_setpc_b64 s[30:31]
L_KB1:
  v_mov_b32 v20, 0
  v_mov_b32 v21, 0
  v_mov_b32 v22, 0
  v_mov_b32 v23, 0
  v_mov_b32 v24, 0
  v_mov_b32 v25, 0
  v_mov_b32 v26, 0
  v_mov_b32 v27, 0
  v_dot2c_f32_bf16 v20, v96, v8
  v_dot2c_f32_bf16 v21, v100, v8
  v_dot2c_f32_bf16 v22, v104, v8
  v_dot2c_f32_bf16 v23, v108, v8
  v_dot2c_f32_bf16 v24, v112, v8
  v_dot2c_f32_bf16 v25, v116, v8
  v_dot2c_f32_bf16 v26, v120, v8
  v_dot2c_f32_bf16 v27, v124, v8
  v_dot2c_f32_bf16 v20, v97, v9
  v_dot2c_f32_bf16 v21, v101, v9
  v_dot2c_f32_bf16 v22, v105, v9
  v_dot2c_f32_bf16 v23, v109, v9
  v_dot2c_f32_bf16 v24, v113, v9
  v_dot2c_f32_bf16 v25, v117, v9
  v_dot2c_f32_bf16 v26, v121, v9
  v_dot2c_f32_bf16 v27, v125, v9
  v_dot2c_f32_bf16 v20, v98, v10
  v_dot2c_f32_bf16 v21, v102, v10
  v_dot2c_f32_bf16 v22, v106, v10
  v_dot2c_f32_bf16 v23, v110, v10
  v_dot2c_f32_bf16 v24, v114, v10
  v_dot2c_f32_bf16 v25, v118, v10
  v_dot2c_f32_bf16 v26, v122, v10
  v_dot2c_f32_bf16 v27, v126, v10
  v_dot2c_f32_bf16 v20, v99, v11
  v_dot2c_f32_bf16 v21, v103, v11
  v_dot2c_f32_bf16 v22, v107, v11
  v_dot2c_f32_bf16 v23, v111, v11
  v_dot2c_f32_bf16 v24, v115, v11
  v_dot2c_f32_bf16 v25, v119, v11
  v_dot2c_f32_bf16 v26, v123, v11
  v_dot2c_f32_bf16 v27, v127, v11
  v_add_f32_dpp v20, v20, v20 row_mirror row_mask:0xf bank_mask:0x3
  v_add_f32_dpp v21, v21, v21 row_mirror row_mask:0xf bank_mask:0x3
  v_add_f32_dpp v22, v22, v22 row_mirror row_mask:0xf bank_mask:0x3
  v_add_f32_dpp v23, v23, v23 row_mirror row_mask:0xf bank_mask:0x3
  v_add_f32_dpp v20, v24, v24 row_mirror row_mask:0xf bank_mask:0xc
  v_add_f32_dpp v21, v25, v25 row_mirror row_mask:0xf bank_mask:0xc
  v_add_f32_dpp v22, v26, v26 row_mirror row_mask:0xf bank_mask:0xc
  v_add_f32_dpp v23, v27, v27 row_mirror row_mask:0xf bank_mask:0xc
  v_add_f32_dpp v20, v20, v20 row_half_mirror row_mask:0xf bank_mask:0x5
  v_add_f32_dpp v21, v21, v21 row_half_mirror row_mask:0xf bank_mask:0x5
  s_nop 0
  v_add_f32_dpp v20, v22, v22 row_half_mirror row_mask:0xf bank_mask:0xa
  v_add_f32_dpp v21, v23, v23 row_half_mirror row_mask:0xf bank_mask:0xa
  s_nop 0
  v_add_f32_dpp v20, v20, v20 quad_perm:[2,3,0,1] row_mask:0xf bank_mask:0xf
  v_add_f32_dpp v21, v21, v21 quad_perm:[2,3,0,1] row_mask:0xf bank_mask:0xf
  v_cndmask_b32 v20, v20, v21, s[34:35]
  s_nop 1
  v_add_f32_dpp v20, v20, v20 quad_perm:[1,0,3,2] row_mask:0xf bank_mask:0xf
  v_cndmask_b32 v28, v30, v20, s[36:37]
  s_setpc_b64 s[30:31]
L_KB2:
  v_mov_b32 v20, 0
  v_mov_b32 v21, 0
  v_mov_b32 v22, 0
  v_mov_b32 v23, 0
  v_mov_b32 v24, 0
  v_mov_b32 v25, 0
  v_mov_b32 v26, 0
  v_mov_b32 v27, 0
  v_dot2c_f32_bf16 v20, v128, v8
  v_dot2c_f32_bf16 v21, v132, v8
  v_dot2c_f32_bf16 v22, v136, v8
  v_dot2c_f32_bf16 v23, v140, v8
  v_dot2c_f32_bf16 v24, v144, v8
  v_dot2c_f32_bf16 v25, v148, v8
  v_dot2c_f32_bf16 v26, v152, v8
  v_dot2c_f32_bf16 v27, v156, v8
  v_dot2c_f32_bf16 v20, v129, v9
  v_dot2c_f32_bf16 v21, v133, v9
  v_dot2c_f32_bf16 v22, v137, v9
  v_dot2c_f32_bf16 v23, v141, v9
  v_dot2c_f32_bf16 v24, v145, v9
  v_dot2c_f32_bf16 v25, v149, v9
  s_branch L_skip3
L_stub3:
  s_setpc_b64 s[30:31]
L_skip3:
  v_dot2c_f32_bf16 v26, v153, v9
  v_dot2c_f32_bf16 v27, v157, v9
  v_dot2c_f32_bf16 v20, v130, v10
  v_dot2c_f32_bf16 v21, v134, v10
  v_dot2c_f32_bf16 v22, v138, v10
  v_dot2c_f32_bf16 v23, v142, v10
  v_dot2c_f32_bf16 v24, v146, v10
  v_dot2c_f32_bf16 v25, v150, v10
  v_dot2c_f32_bf16 v26, v154, v10
  v_dot2c_f32_bf16 v27, v158, v10
  v_dot2c_f32_bf16 v20, v131, v11
  v_dot2c_f32_bf16 v21, v135, v11
  v_dot2c_f32_bf16 v22, v139, v11
  v_dot2c_f32_bf16 v23, v143, v11
  v_dot2c_f32_bf16 v24, v147, v11
  v_dot2c_f32_bf16 v25, v151, v11
  v_dot2c_f32_bf16 v26, v155, v11
  v_dot2c_f32_bf16 v27, v159, v11
  v_add_f32_dpp v20, v20, v20 row_mirror row_mask:0xf bank_mask:0x3
  v_add_f32_dpp v21, v21, v21 row_mirror row_mask:0xf bank_mask:0x3
  v_add_f32_dpp v22, v22, v22 row_mirror row_mask:0xf bank_mask:0x3
  v_add_f32_dpp v23, v23, v23 row_mirror row_mask:0xf bank_mask:0x3
  v_add_f32_dpp v20, v24, v24 row_mirror row_mask:0xf bank_mask:0xc
  v_add_f32_dpp v21, v25, v25 row_mirror row_mask:0xf bank_mask:0xc
  v_add_f32_dpp v22, v26, v26 row_mirror row_mask:0xf bank_mask:0xc
  v_add_f32_dpp v23, v27, v27 row_mirror row_mask:0xf bank_mask:0xc
  v_add_f32_dpp v20, v20, v20 row_half_mirror row_mask:0xf bank_mask:0x5
  v_add_f32_dpp v21, v21, v21 row_half_mirror row_mask:0xf bank_mask:0x5
  s_nop 0
  v_add_f32_dpp v20, v22, v22 row_half_mirror row_mask:0xf bank_mask:0xa
  v_add_f32_dpp v21, v23, v23 row_half_mirror row_mask:0xf bank_mask:0xa
  s_nop 0
  v_add_f32_dpp v20, v20, v20 quad_perm:[2,3,0,1] row_mask:0xf bank_mask:0xf
  v_add_f32_dpp v21, v21, v21 quad_perm:[2,3,0,1] row_mask:0xf bank_mask:0xf
  v_cndmask_b32 v20, v20, v21, s[34:35]
  s_nop 1
  v_add_f32_dpp v30, v20, v20 quad_perm:[1,0,3,2] row_mask:0xf bank_mask:0xf
  s_setpc_b64 s[30:31]
L_KB3:
  v_mov_b32 v20, 0
  v_mov_b32 v21, 0
  v_mov_b32 v22, 0
  v_mov_b32 v23, 0
  v_mov_b32 v24, 0
  v_mov_b32 v25, 0
  v_mov_b32 v26, 0
  v_mov_b32 v27, 0
  v_dot2c_f32_bf16 v20, v160, v8
  v_dot2c_f32_bf16 v21, v164, v8
  v_dot2c_f32_bf16 v22, v168, v8
  v_dot2c_f32_bf16 v23, v172, v8
  v_dot2c_f32_bf16 v24, v176, v8
  v_dot2c_f32_bf16 v25, v180, v8
  v_dot2c_f32_bf16 v26, v184, v8
  v_dot2c_f32_bf16 v27, v188, v8
  v_dot2c_f32_bf16 v20, v161, v9
  v_dot2c_f32_bf16 v21, v165, v9
  v_dot2c_f32_bf16 v22, v169, v9
  v_dot2c_f32_bf16 v23, v173, v9
  v_dot2c_f32_bf16 v24, v177, v9
  v_dot2c_f32_bf16 v25, v181, v9
  v_dot2c_f32_bf16 v26, v185, v9
  v_dot2c_f32_bf16 v27, v189, v9
  v_dot2c_f32_bf16 v20, v162, v10
  v_dot2c_f32_bf16 v21, v166, v10
  v_dot2c_f32_bf16 v22, v170, v10
  v_dot2c_f32_bf16 v23, v174, v10
  v_dot2c_f32_bf16 v24, v178, v10
  v_dot2c_f32_bf16 v25, v182, v10
  v_dot2c_f32_bf16 v26, v186, v10
  v_dot2c_f32_bf16 v27, v190, v10
  v_dot2c_f32_bf16 v20, v163, v11
  v_dot2c_f32_bf16 v21, v167, v11
  v_dot2c_f32_bf16 v22, v171, v11
  v_dot2c_f32_bf16 v23, v175, v11
  v_dot2c_f32_bf16 v24, v179, v11
  v_dot2c_f32_bf16 v25, v183, v11
  v_dot2c_f32_bf16 v26, v187, v11
  v_dot2c_f32_bf16 v27, v191, v11
  v_add_f32_dpp v20, v20, v20 row_mirror row_mask:0xf bank_mask:0x3
  v_add_f32_dpp v21, v21, v21 row_mirror row_mask:0xf bank_mask:0x3
  v_add_f32_dpp v22, v22, v22 row_mirror row_mask:0xf bank_mask:0x3
  v_add_f32_dpp v23, v23, v23 row_mirror row_mask:0xf bank_mask:0x3
  v_add_f32_dpp v20, v24, v24 row_mirror row_mask:0xf bank_mask:0xc
  v_add_f32_dpp v21, v25, v25 row_mirror row_mask:0xf bank_mask:0xc
  v_add_f32_dpp v22, v26, v26 row_mirror row_mask:0xf bank_mask:0xc
  v_add_f32_dpp v23, v27, v27 row_mirror row_mask:0xf bank_mask:0xc
  v_add_f32_dpp v20, v20, v20 row_half_mirror row_mask:0xf bank_mask:0x5
  v_add_f32_dpp v21, v21, v21 row_half_mirror row_mask:0xf bank_mask:0x5
  s_nop 0
  v_add_f32_dpp v20, v22, v22 row_half_mirror row_mask:0xf bank_mask:0xa
  v_add_f32_dpp v21, v23, v23 row_half_mirror row_mask:0xf bank_mask:0xa
  s_nop 0
  v_add_f32_dpp v20, v20, v20 quad_perm:[2,3,0,1] row_mask:0xf bank_mask:0xf
  v_add_f32_dpp v21, v21, v21 quad_perm:[2,3,0,1] row_mask:0xf bank_mask:0xf
  v_cndmask_b32 v20, v20, v21, s[34:35]
  s_nop 1
  v_add_f32_dpp v20, v20, v20 quad_perm:[1,0,3,2] row_mask:0xf bank_mask:0xf
  v_cndmask_b32 v29, v30, v20, s[36:37]
  s_setpc_b64 s[30:31]
L_WS0:
  s_nop 1
  v_mov_b32_dpp v34, v32 row_newbcast:0 row_mask:0xf bank_mask:0xf
  v_lshlrev_b32 v35, 16, v34
  v_dot2c_f32_bf16 v12, v64, v34
  v_dot2c_f32_bf16 v13, v64, v35
  v_dot2c_f32_bf16 v14, v65, v34
  v_dot2c_f32_bf16 v15, v65, v35
  v_dot2c_f32_bf16 v16, v66, v34
  v_dot2c_f32_bf16 v17, v66, v35
  v_dot2c_f32_bf16 v18, v67, v34
  v_dot2c_f32_bf16 v19, v67, v35
  v_mov_b32_dpp v34, v32 row_newbcast:2 row_mask:0xf bank_mask:0xf
  v_lshlrev_b32 v35, 16, v34
  v_dot2c_f32_bf16 v12, v68, v34
  v_dot2c_f32_bf16 v13, v68, v35
  v_dot2c_f32_bf16 v14, v69, v34
  v_dot2c_f32_bf16 v15, v69, v35
  v_dot2c_f32_bf16 v16, v70, v34
  v_dot2c_f32_bf16 v17, v70, v35
  v_dot2c_f32_bf16 v18, v71, v34
  v_dot2c_f32_bf16 v19, v71, v35
  v_mov_b32_dpp v34, v32 row_newbcast:4 row_mask:0xf bank_mask:0xf
  v_lshlrev_b32 v35, 16, v34
  v_dot2c_f32_bf16 v12, v72, v34
  v_dot2c_f32_bf16 v13, v72, v35
  v_dot2c_f32_bf16 v14, v73, v34
  v_dot2c_f32_bf16 v15, v73, v35
  v_dot2c_f32_bf16 v16, v74, v34
  v_dot2c_f32_bf16 v17, v74, v35
  v_dot2c_f32_bf16 v18, v75, v34
  v_dot2c_f32_bf16 v19, v75, v35
  v_mov_b32_dpp v34, v32 row_newbcast:6 row_mask:0xf bank_mask:0xf
  v_lshlrev_b32 v35, 16, v34
  v_dot2c_f32_bf16 v12, v76, v34
  v_dot2c_f32_bf16 v13, v76, v35
  v_dot2c_f32_bf16 v14, v77, v34
  v_dot2c_f32_bf16 v15, v77, v35
  v_dot2c_f32_bf16 v16, v78, v34
  v_dot2c_f32_bf16 v17, v78, v35
  v_dot2c_f32_bf16 v18, v79, v34
  v_dot2c_f32_bf16 v19, v79, v35
  v_mov_b32_dpp v34, v32 row_newbcast:8 row_mask:0xf bank_mask:0xf
  v_lshlrev_b32 v35, 16, v34
  v_dot2c_f32_bf16 v12, v80, v34
  v_dot2c_f32_bf16 v13, v80, v35
  v_dot2c_f32_bf16 v14, v81, v34
  v_dot2c_f32_bf16 v15, v81, v35
  v_dot2c_f32_bf16 v16, v82, v34
  v_dot2c_f32_bf16 v17, v82, v35
  v_dot2c_f32_bf16 v18, v83, v34
  v_dot2c_f32_bf16 v19, v83, v35
  v_mov_b32_dpp v34, v32 row_newbcast:10 row_mask:0xf bank_mask:0xf
  v_lshlrev_b32 v35, 16, v34
  v_dot2c_f32_bf16 v12, v84, v34
  v_dot2c_f32_bf16 v13, v84, v35
  v_dot2c_f32_bf16 v14, v85, v34
  v_dot2c_f32_bf16 v15, v85, v35
  v_dot2c_f32_bf16 v16, v86, v34
  v_dot2c_f32_bf16 v17, v86, v35
  v_dot2c_f32_bf16 v18, v87, v34
  v_dot2c_f32_bf16 v19, v87, v35
  v_mov_b32_dpp v34, v32 row_newbcast:12 row_mask:0xf bank_mask:0xf
  v_lshlrev_b32 v35, 16, v34
  v_dot2c_f32_bf16 v12, v88, v34
  v_dot2c_f32_bf16 v13, v88, v35
  v_dot2c_f32_bf16 v14, v89, v34
  v_dot2c_f32_bf16 v15, v89, v35
  v_dot2c_f32_bf16 v16, v90, v34
  v_dot2c_f32_bf16 v17, v90, v35
  v_dot2c_f32_bf16 v18, v91, v34
  v_dot2c_f32_bf16 v19, v91, v35
  v_mov_b32_dpp v34, v32 row_newbcast:14 row_mask:0xf bank_mask:0xf
  v_lshlrev_b32 v35, 16, v34
  v_dot2c_f32_bf16 v12, v92, v34
  v_dot2c_f32_bf16 v13, v92, v35
  v_dot2c_f32_bf16 v14, v93, v34
  v_dot2c_f32_bf16 v15, v93, v35
  v_dot2c_f32_bf16 v16, v94, v34
  v_dot2c_f32_bf16 v17, v94, v35
  v_dot2c_f32_bf16 v18, v95, v34
  v_dot2c_f32_bf16 v19, v95, v35
  s_nop 1
  s_setpc_b64 s[30:31]
L_WS1:
  s_nop 1
  v_mov_b32_dpp v34, v32 row_newbcast:1 row_mask:0xf bank_mask:0xf
  v_lshlrev_b32 v35, 16, v34
  v_dot2c_f32_bf16 v12, v96, v34
  v_dot2c_f32_bf16 v13, v96, v35
  v_dot2c_f32_bf16 v14, v97, v34
  v_dot2c_f32_bf16 v15, v97, v35
  v_dot2c_f32_bf16 v16, v98, v34
  v_dot2c_f32_bf16 v17, v98, v35
  v_dot2c_f32_bf16 v18, v99, v34
  v_dot2c_f32_bf16 v19, v99, v35
  v_mov_b32_dpp v34, v32 row_newbcast:3 row_mask:0xf bank_mask:0xf
  v_lshlrev_b32 v35, 16, v34
  v_dot2c_f32_bf16 v12, v100, v34
  v_dot2c_f32_bf16 v13, v100, v35
  v_dot2c_f32_bf16 v14, v101, v34
  v_dot2c_f32_bf16 v15, v101, v35
  v_dot2c_f32_bf16 v16, v102, v34
  v_dot2c_f32_bf16 v17, v102, v35
  v_dot2c_f32_bf16 v18, v103, v34
  v_dot2c_f32_bf16 v19, v103, v35
  v_mov_b32_dpp v34, v32 row_newbcast:5 row_mask:0xf bank_mask:0xf
  v_lshlrev_b32 v35, 16, v34
  v_dot2c_f32_bf16 v12, v104, v34
  v_dot2c_f32_bf16 v13, v104, v35
  v_dot2c_f32_bf16 v14, v105, v34
  v_dot2c_f32_bf16 v15, v105, v35
  v_dot2c_f32_bf16 v16, v106, v34
  s_branch L_skip4
L_stub4:
  s_setpc_b64 s[30:31]
L_skip4:
  v_dot2c_f32_bf16 v17, v106, v35
  v_dot2c_f32_bf16 v18, v107, v34
  v_dot2c_f32_bf16 v19, v107, v35
  v_mov_b32_dpp v34, v32 row_newbcast:7 row_mask:0xf bank_mask:0xf
  v_lshlrev_b32 v35, 16, v34
  v_dot2c_f32_bf16 v12, v108, v34
  v_dot2c_f32_bf16 v13, v108, v35
  v_dot2c_f32_bf16 v14, v109, v34
  v_dot2c_f32_bf16 v15, v109, v35
  v_dot2c_f32_bf16 v16, v110, v34
  v_dot2c_f32_bf16 v17, v110, v35
  v_dot2c_f32_bf16 v18, v111, v34
  v_dot2c_f32_bf16 v19, v111, v35
  v_mov_b32_dpp v34, v32 row_newbcast:9 row_mask:0xf bank_mask:0xf
  v_lshlrev_b32 v35, 16, v34
  v_dot2c_f32_bf16 v12, v112, v34
  v_dot2c_f32_bf16 v13, v112, v35
  v_dot2c_f32_bf16 v14, v113, v34
  v_dot2c_f32_bf16 v15, v113, v35
  v_dot2c_f32_bf16 v16, v114, v34
  v_dot2c_f32_bf16 v17, v114, v35
  v_dot2c_f32_bf16 v18, v115, v34
  v_dot2c_f32_bf16 v19, v115, v35
  v_mov_b32_dpp v34, v32 row_newbcast:11 row_mask:0xf bank_mask:0xf
  v_lshlrev_b32 v35, 16, v34
  v_dot2c_f32_bf16 v12, v116, v34
  v_dot2c_f32_bf16 v13, v116, v35
  v_dot2c_f32_bf16 v14, v117, v34
  v_dot2c_f32_bf16 v15, v117, v35
  v_dot2c_f32_bf16 v16, v118, v34
  v_dot2c_f32_bf16 v17, v118, v35
  v_dot2c_f32_bf16 v18, v119, v34
  v_dot2c_f32_bf16 v19, v119, v35
  v_mov_b32_dpp v34, v32 row_newbcast:13 row_mask:0xf bank_mask:0xf
  v_lshlrev_b32 v35, 16, v34
  v_dot2c_f32_bf16 v12, v120, v34
  v_dot2c_f32_bf16 v13, v120, v35
  v_dot2c_f32_bf16 v14, v121, v34
  v_dot2c_f32_bf16 v15, v121, v35
  v_dot2c_f32_bf16 v16, v122, v34
  v_dot2c_f32_bf16 v17, v122, v35
  v_dot2c_f32_bf16 v18, v123, v34
  v_dot2c_f32_bf16 v19, v123, v35
  v_mov_b32_dpp v34, v32 row_newbcast:15 row_mask:0xf bank_mask:0xf
  v_lshlrev_b32 v35, 16, v34
  v_dot2c_f32_bf16 v12, v124, v34
  v_dot2c_f32_bf16 v13, v124, v35
  v_dot2c_f32_bf16 v14, v125, v34
  v_dot2c_f32_bf16 v15, v125, v35
  v_dot2c_f32_bf16 v16, v126, v34
  v_dot2c_f32_bf16 v17, v126, v35
  v_dot2c_f32_bf16 v18, v127, v34
  v_dot2c_f32_bf16 v19, v127, v35
  s_nop 1
  s_setpc_b64 s[30:31]
L_WS2:
  s_nop 1
  v_mov_b32_dpp v34, v33 row_newbcast:0 row_mask:0xf bank_mask:0xf
  v_lshlrev_b32 v35, 16, v34
  v_dot2c_f32_bf16 v12, v128, v34
  v_dot2c_f32_bf16 v13, v128, v35
  v_dot2c_f32_bf16 v14, v129, v34
  v_dot2c_f32_bf16 v15, v129, v35
  v_dot2c_f32_bf16 v16, v130, v34
  v_dot2c_f32_bf16 v17, v130, v35
  v_dot2c_f32_bf16 v18, v131, v34
  v_dot2c_f32_bf16 v19, v131, v35
  v_mov_b32_dpp v34, v33 row_newbcast:2 row_mask:0xf bank_mask:0xf
  v_lshlrev_b32 v35, 16, v34
  v_dot2c_f32_bf16 v12, v132, v34
  v_dot2c_f32_bf16 v13, v132, v35
  v_dot2c_f32_bf16 v14, v133, v34
  v_dot2c_f32_bf16 v15, v133, v35
  v_dot2c_f32_bf16 v16, v134, v34
  v_dot2c_f32_bf16 v17, v134, v35
  v_dot2c_f32_bf16 v18, v135, v34
  v_dot2c_f32_bf16 v19, v135, v35
  v_mov_b32_dpp v34, v33 row_newbcast:4 row_mask:0xf bank_mask:0xf
  v_lshlrev_b32 v35, 16, v34
  v_dot2c_f32_bf16 v12, v136, v34
  v_dot2c_f32_bf16 v13, v136, v35
  v_dot2c_f32_bf16 v14, v137, v34
  v_dot2c_f32_bf16 v15, v137, v35
  v_dot2c_f32_bf16 v16, v138, v34
  v_dot2c_f32_bf16 v17, v138, v35
  v_dot2c_f32_bf16 v18, v139, v34
  v_dot2c_f32_bf16 v19, v139, v35
  v_mov_b32_dpp v34, v33 row_newbcast:6 row_mask:0xf bank_mask:0xf
  v_lshlrev_b32 v35, 16, v34
  v_dot2c_f32_bf16 v12, v140, v34
  v_dot2c_f32_bf16 v13, v140, v35
  v_dot2c_f32_bf16 v14, v141, v34
  v_dot2c_f32_bf16 v15, v141, v35
  v_dot2c_f32_bf16 v16, v142, v34
  v_dot2c_f32_bf16 v17, v142, v35
  v_dot2c_f32_bf16 v18, v143, v34
  v_dot2c_f32_bf16 v19, v143, v35
  v_mov_b32_dpp v34, v33 row_newbcast:8 row_mask:0xf bank_mask:0xf
  v_lshlrev_b32 v35, 16, v34
  v_dot2c_f32_bf16 v12, v144, v34
  v_dot2c_f32_bf16 v13, v144, v35
  v_dot2c_f32_bf16 v14, v145, v34
  v_dot2c_f32_bf16 v15, v145, v35
  v_dot2c_f32_bf16 v16, v146, v34
  v_dot2c_f32_bf16 v17, v146, v35
  v_dot2c_f32_bf16 v18, v147, v34
  v_dot2c_f32_bf16 v19, v147, v35
  v_mov_b32_dpp v34, v33 row_newbcast:10 row_mask:0xf bank_mask:0xf
  v_lshlrev_b32 v35, 16, v34
  v_dot2c_f32_bf16 v12, v148, v34
  v_dot2c_f32_bf16 v13, v148, v35
  v_dot2c_f32_bf16 v14, v149, v34
  v_dot2c_f32_bf16 v15, v149, v35
  v_dot2c_f32_bf16 v16, v150, v34
  v_dot2c_f32_bf16 v17, v150, v35
  v_dot2c_f32_bf16 v18, v151, v34
  v_dot2c_f32_bf16 v19, v151, v35
  v_mov_b32_dpp v34, v33 row_newbcast:12 row_mask:0xf bank_mask:0xf
  v_lshlrev_b32 v35, 16, v34
  v_dot2c_f32_bf16 v12, v152, v34
  v_dot2c_f32_bf16 v13, v152, v35
  v_dot2c_f32_bf16 v14, v153, v34
  v_dot2c_f32_bf16 v15, v153, v35
  v_dot2c_f32_bf16 v16, v154, v34
  v_dot2c_f32_bf16 v17, v154, v35
  v_dot2c_f32_bf16 v18, v155, v34
  v_dot2c_f32_bf16 v19, v155, v35
  v_mov_b32_dpp v34, v33 row_newbcast:14 row_mask:0xf bank_mask:0xf
  v_lshlrev_b32 v35, 16, v34
  v_dot2c_f32_bf16 v12, v156, v34
  v_dot2c_f32_bf16 v13, v156, v35
  v_dot2c_f32_bf16 v14, v157, v34
  v_dot2c_f32_bf16 v15, v157, v35
  v_dot2c_f32_bf16 v16, v158, v34
  v_dot2c_f32_bf16 v17, v158, v35
  v_dot2c_f32_bf16 v18, v159, v34
  v_dot2c_f32_bf16 v19, v159, v35
  s_nop 1
  s_setpc_b64 s[30:31]
L_WS3:
  s_nop 1
  v_mov_b32_dpp v34, v33 row_newbcast:1 row_mask:0xf bank_mask:0xf
  v_lshlrev_b32 v35, 16, v34
  v_dot2c_f32_bf16 v12, v160, v34
  v_dot2c_f32_bf16 v13, v160, v35
  v_dot2c_f32_bf16 v14, v161, v34
  v_dot2c_f32_bf16 v15, v161, v35
  v_dot2c_f32_bf16 v16, v162, v34
  v_dot2c_f32_bf16 v17, v162, v35
  v_dot2c_f32_bf16 v18, v163, v34
  v_dot2c_f32_bf16 v19, v163, v35
  v_mov_b32_dpp v34, v33 row_newbcast:3 row_mask:0xf bank_mask:0xf
  v_lshlrev_b32 v35, 16, v34
  v_dot2c_f32_bf16 v12, v164, v34
  v_dot2c_f32_bf16 v13, v164, v35
  v_dot2c_f32_bf16 v14, v165, v34
  v_dot2c_f32_bf16 v15, v165, v35
  v_dot2c_f32_bf16 v16, v166, v34
  v_dot2c_f32_bf16 v17, v166, v35
  v_dot2c_f32_bf16 v18, v167, v34
  v_dot2c_f32_bf16 v19, v167, v35
  v_mov_b32_dpp v34, v33 row_newbcast:5 row_mask:0xf bank_mask:0xf
  v_lshlrev_b32 v35, 16, v34
  v_dot2c_f32_bf16 v12, v168, v34
  v_dot2c_f32_bf16 v13, v168, v35
  v_dot2c_f32_bf16 v14, v169, v34
  v_dot2c_f32_bf16 v15, v169, v35
  v_dot2c_f32_bf16 v16, v170, v34
  v_dot2c_f32_bf16 v17, v170, v35
  v_dot2c_f32_bf16 v18, v171, v34
  v_dot2c_f32_bf16 v19, v171, v35
  v_mov_b32_dpp v34, v33 row_newbcast:7 row_mask:0xf bank_mask:0xf
  v_lshlrev_b32 v35, 16, v34
  v_dot2c_f32_bf16 v12, v172, v34
  v_dot2c_f32_bf16 v13, v172, v35
  v_dot2c_f32_bf16 v14, v173, v34
  v_dot2c_f32_bf16 v15, v173, v35
  v_dot2c_f32_bf16 v16, v174, v34
  v_dot2c_f32_bf16 v17, v174, v35
  v_dot2c_f32_bf16 v18, v175, v34
  v_dot2c_f32_bf16 v19, v175, v35
  v_mov_b32_dpp v34, v33 row_newbcast:9 row_mask:0xf bank_mask:0xf
  v_lshlrev_b32 v35, 16, v34
  v_dot2c_f32_bf16 v12, v176, v34
  v_dot2c_f32_bf16 v13, v176, v35
  v_dot2c_f32_bf16 v14, v177, v34
  v_dot2c_f32_bf16 v15, v177, v35
  v_dot2c_f32_bf16 v16, v178, v34
  v_dot2c_f32_bf16 v17, v178, v35
  v_dot2c_f32_bf16 v18, v179, v34
  v_dot2c_f32_bf16 v19, v179, v35
  v_mov_b32_dpp v34, v33 row_newbcast:11 row_mask:0xf bank_mask:0xf
  v_lshlrev_b32 v35, 16, v34
  v_dot2c_f32_bf16 v12, v180, v34
  v_dot2c_f32_bf16 v13, v180, v35
  v_dot2c_f32_bf16 v14, v181, v34
  v_dot2c_f32_bf16 v15, v181, v35
  v_dot2c_f32_bf16 v16, v182, v34
  v_dot2c_f32_bf16 v17, v182, v35
  v_dot2c_f32_bf16 v18, v183, v34
  v_dot2c_f32_bf16 v19, v183, v35
  v_mov_b32_dpp v34, v33 row_newbcast:13 row_mask:0xf bank_mask:0xf
  v_lshlrev_b32 v35, 16, v34
  v_dot2c_f32_bf16 v12, v184, v34
  v_dot2c_f32_bf16 v13, v184, v35
  v_dot2c_f32_bf16 v14, v185, v34
  v_dot2c_f32_bf16 v15, v185, v35
  v_dot2c_f32_bf16 v16, v186, v34
  v_dot2c_f32_bf16 v17, v186, v35
  v_dot2c_f32_bf16 v18, v187, v34
  v_dot2c_f32_bf16 v19, v187, v35
  v_mov_b32_dpp v34, v33 row_newbcast:15 row_mask:0xf bank_mask:0xf
  v_lshlrev_b32 v35, 16, v34
  v_dot2c_f32_bf16 v12, v188, v34
  v_dot2c_f32_bf16 v13, v188, v35
  v_dot2c_f32_bf16 v14, v189, v34
  v_dot2c_f32_bf16 v15, v189, v35
  v_dot2c_f32_bf16 v16, v190, v34
  v_dot2c_f32_bf16 v17, v190, v35
  v_dot2c_f32_bf16 v18, v191, v34
  v_dot2c_f32_bf16 v19, v191, v35
  s_nop 1
  s_setpc_b64 s[30:31]
L_WS3L:
  s_nop 1
  v_mov_b32_dpp v34, v33 row_newbcast:1 row_mask:0xf bank_mask:0xf
  v_lshlrev_b32 v35, 16, v34
  s_waitcnt vmcnt(7)
  v_dot2c_f32_bf16 v12, v160, v34
  v_dot2c_f32_bf16 v13, v160, v35
  v_dot2c_f32_bf16 v14, v161, v34
  v_dot2c_f32_bf16 v15, v161, v35
  v_dot2c_f32_bf16 v16, v162, v34
  v_dot2c_f32_bf16 v17, v162, v35
  v_dot2c_f32_bf16 v18, v163, v34
  s_branch L_skip5
L_stub5:
  s_setpc_b64 s[30:31]
L_skip5:
  v_dot2c_f32_bf16 v19, v163, v35
  v_mov_b32_dpp v34, v33 row_newbcast:3 row_mask:0xf bank_mask:0xf
  v_lshlrev_b32 v35, 16, v34
  s_waitcnt vmcnt(6)
  v_dot2c_f32_bf16 v12, v164, v34
  v_dot2c_f32_bf16 v13, v164, v35
  v_dot2c_f32_bf16 v14, v165, v34
  v_dot2c_f32_bf16 v15, v165, v35
  v_dot2c_f32_bf16 v16, v166, v34
  v_dot2c_f32_bf16 v17, v166, v35
  v_dot2c_f32_bf16 v18, v167, v34
  v_dot2c_f32_bf16 v19, v167, v35
  v_mov_b32_dpp v34, v33 row_newbcast:5 row_mask:0xf bank_mask:0xf
  v_lshlrev_b32 v35, 16, v34
  s_waitcnt vmcnt(5)
  v_dot2c_f32_bf16 v12, v168, v34
  v_dot2c_f32_bf16 v13, v168, v35
  v_dot2c_f32_bf16 v14, v169, v34
  v_dot2c_f32_bf16 v15, v169, v35
  v_dot2c_f32_bf16 v16, v170, v34
  v_dot2c_f32_bf16 v17, v170, v35
  v_dot2c_f32_bf16 v18, v171, v34
  v_dot2c_f32_bf16 v19, v171, v35
  v_mov_b32_dpp v34, v33 row_newbcast:7 row_mask:0xf bank_mask:0xf
  v_lshlrev_b32 v35, 16, v34
  s_waitcnt vmcnt(4)
  v_dot2c_f32_bf16 v12, v172, v34
  v_dot2c_f32_bf16 v13, v172, v35
  v_dot2c_f32_bf16 v14, v173, v34
  v_dot2c_f32_bf16 v15, v173, v35
  v_dot2c_f32_bf16 v16, v174, v34
  v_dot2c_f32_bf16 v17, v174, v35
  v_dot2c_f32_bf16 v18, v175, v34
  v_dot2c_f32_bf16 v19, v175, v35
  v_mov_b32_dpp v34, v33 row_newbcast:9 row_mask:0xf bank_mask:0xf
  v_lshlrev_b32 v35, 16, v34
  s_waitcnt vmcnt(3)
  v_dot2c_f32_bf16 v12, v176, v34
  v_dot2c_f32_bf16 v13, v176, v35
  v_dot2c_f32_bf16 v14, v177, v34
  v_dot2c_f32_bf16 v15, v177, v35
  v_dot2c_f32_bf16 v16, v178, v34
  v_dot2c_f32_bf16 v17, v178, v35
  v_dot2c_f32_bf16 v18, v179, v34
  v_dot2c_f32_bf16 v19, v179, v35
  v_mov_b32_dpp v34, v33 row_newbcast:11 row_mask:0xf bank_mask:0xf
  v_lshlrev_b32 v35, 16, v34
  s_waitcnt vmcnt(2)
  v_dot2c_f32_bf16 v12, v180, v34
  v_dot2c_f32_bf16 v13, v180, v35
  v_dot2c_f32_bf16 v14, v181, v34
  v_dot2c_f32_bf16 v15, v181, v35
  v_dot2c_f32_bf16 v16, v182, v34
  v_dot2c_f32_bf16 v17, v182, v35
  v_dot2c_f32_bf16 v18, v183, v34
  v_dot2c_f32_bf16 v19, v183, v35
  v_mov_b32_dpp v34, v33 row_newbcast:13 row_mask:0xf bank_mask:0xf
  v_lshlrev_b32 v35, 16, v34
  s_waitcnt vmcnt(1)
  v_dot2c_f32_bf16 v12, v184, v34
  v_dot2c_f32_bf16 v13, v184, v35
  v_dot2c_f32_bf16 v14, v185, v34
  v_dot2c_f32_bf16 v15, v185, v35
  v_dot2c_f32_bf16 v16, v186, v34
  v_dot2c_f32_bf16 v17, v186, v35
  v_dot2c_f32_bf16 v18, v187, v34
  v_dot2c_f32_bf16 v19, v187, v35
  v_mov_b32_dpp v34, v33 row_newbcast:15 row_mask:0xf bank_mask:0xf
  v_lshlrev_b32 v35, 16, v34
  s_waitcnt vmcnt(0)
  v_dot2c_f32_bf16 v12, v188, v34
  v_dot2c_f32_bf16 v13, v188, v35
  v_dot2c_f32_bf16 v14, v189, v34
  v_dot2c_f32_bf16 v15, v189, v35
  v_dot2c_f32_bf16 v16, v190, v34
  v_dot2c_f32_bf16 v17, v190, v35
  v_dot2c_f32_bf16 v18, v191, v34
  v_dot2c_f32_bf16 v19, v191, v35
  s_nop 1
  s_setpc_b64 s[30:31]
L_RED8:
  s_nop 1
  v_permlane32_swap_b32 v12, v16
  v_permlane32_swap_b32 v13, v17
  v_permlane32_swap_b32 v14, v18
  v_permlane32_swap_b32 v15, v19
  v_add_f32 v12, v12, v16
  v_add_f32 v13, v13, v17
  v_add_f32 v14, v14, v18
  v_add_f32 v15, v15, v19
  s_nop 0
  v_permlane16_swap_b32 v12, v14
  v_permlane16_swap_b32 v13, v15
  v_add_f32 v12, v12, v14
  v_add_f32 v13, v13, v15
  s_setpc_b64 s[30:31]
L_PUBML:
  v_mov_b32 v44, v48
  v_mov_b32 v45, s28
  v_mov_b32 v46, v49
  v_mov_b32 v47, s29
  v_lshlrev_b32 v4, 4, v1
  s_mov_b64 exec, 0xff
  buffer_store_dwordx4 v[44:47], v4, s[16:19], s44 offen offset:512
  s_mov_b64 exec, -1
  s_nop 0
  s_setpc_b64 s[30:31]
L_PUBPART:
  v_rcp_f32 v4, v49
  v_lshrrev_b32 v5, 1, v51
  v_lshlrev_b32 v5, 4, v5
  v_add_lshl_u32 v5, v5, v50, s91
  v_mul_f32 v12, v12, v4
  v_mul_f32 v13, v13, v4
  v_cvt_pk_bf16_f32 v44, v12, v13
  v_mov_b32 v45, s28
  v_mov_b32 v46, v44
  v_mov_b32 v47, s29
  s_nop 0
  v_permlane16_swap_b32 v44, v46
  s_mov_b32 exec_lo, 0xffff
  s_mov_b32 exec_hi, 0xffff
  buffer_store_dwordx4 v[44:47], v5, s[16:19], s90 offen
  s_mov_b64 exec, -1
  s_nop 0
  s_setpc_b64 s[30:31]
L_PUBY:
  s_lshl_b32 s25, s42, 11
  v_lshl_add_u32 v4, v1, 3, s25
  ds_read_b64 v[20:21], v4 offset:10240
  ds_read_b64 v[22:23], v4 offset:10752
  ds_read_b64 v[24:25], v4 offset:11264
  ds_read_b64 v[26:27], v4 offset:11776
  s_lshl_b32 s25, s42, 3
  s_add_u32 s26, s25, s10
  s_lshl_b32 s26, s26, 5
  s_add_u32 s26, s26, s96
  s_lshl_b32 s26, s26, 10
  s_add_u32 s26, s26, 65536
  v_lshlrev_b32 v5, 4, v1
  v_mov_b32 v45, s28
  v_mov_b32 v47, s29
  s_waitcnt lgkmcnt(0)
  v_add_f32 v44, v20, v22
  v_add_f32 v46, v21, v23
  v_add_f32 v24, v24, v26
  v_add_f32 v25, v25, v27
  v_add_f32 v44, v44, v24
  v_add_f32 v46, v46, v25
  buffer_store_dwordx4 v[44:47], v5, s[16:19], s26 offen sc1
  s_nop 0
  s_setpc_b64 s[30:31]
L_QC:
  v_lshlrev_b32 v2, 4, v1
  v_add_u32 v3, 0x1000, v2
  s_add_u32 s26, s26, 1048576
  s_mov_b32 s41, 32768
  v_and_b32 v4, 7, v1
  v_lshlrev_b32 v4, 10, v4
L_QC_hint:
  s_mov_b64 exec, 0xff
  buffer_load_dwordx4 v[64:67], v4, s[16:19], s26 offen offset:1008 nt
  s_waitcnt vmcnt(0)
  v_xor_b32 v53, s28, v65
  v_xor_b32 v54, s29, v67
  v_or_b32 v52, v53, v54
  v_cmp_ne_u32 vcc, 0, v52
  s_mov_b64 exec, -1
  s_cbranch_vccz L_QC_hok
  s_cmp_eq_u32 s42, 0
  s_cbranch_scc0 L_QC_hok_nb
  s_sleep 32
L_QC_hok_nb:
  s_cmp_gt_u32 s41, 32744
  s_cbranch_scc1 L_QC_hok_fast
  buffer_wbl2 sc1
  s_waitcnt vmcnt(0)
  s_sleep 16
L_QC_hok_fast:
  s_sub_u32 s41, s41, 1
  s_cbranch_scc0 L_QC_hint
L_QC_hok:
  s_mov_b32 s41, 32768
L_QC_poll:
  buffer_load_dwordx4 v[64:67], v2, s[16:19], s26 offen offset:0 nt
  buffer_load_dwordx4 v[68:71], v2, s[16:19], s26 offen offset:1024 nt
  buffer_load_dwordx4 v[72:75], v2, s[16:19], s26 offen offset:2048 nt
  buffer_load_dwordx4 v[76:79], v2, s[16:19], s26 offen offset:3072 nt
  s_waitcnt vmcnt(3)
  buffer_load_dwordx4 v[80:83], v3, s[16:19], s26 offen offset:0 nt
  s_waitcnt vmcnt(3)
  buffer_load_dwordx4 v[84:87], v3, s[16:19], s26 offen offset:1024 nt
  s_waitcnt vmcnt(3)
  buffer_load_dwordx4 v[88:91], v3, s[16:19], s26 offen offset:2048 nt
  s_waitcnt vmcnt(3)
  buffer_load_dwordx4 v[92:95], v3, s[16:19], s26 offen offset:3072 nt
  s_waitcnt vmcnt(0)
  v_xor_b32 v53, s28, v65
  v_xor_b32 v54, s29, v67
  v_or_b32 v52, v53, v54
  v_xor_b32 v53, s28, v69
  v_xor_b32 v54, s29, v71
  v_or3_b32 v52, v52, v53, v54
  v_xor_b32 v53, s28, v73
  v_xor_b32 v54, s29, v75
  v_or3_b32 v52, v52, v53, v54
  v_xor_b32 v53, s28, v77
  v_xor_b32 v54, s29, v79
  v_or3_b32 v52, v52, v53, v54
  v_xor_b32 v53, s28, v81
  v_xor_b32 v54, s29, v83
  v_or3_b32 v52, v52, v53, v54
  v_xor_b32 v53, s28, v85
  v_xor_b32 v54, s29, v87
  v_or3_b32 v52, v52, v53, v54
  v_xor_b32 v53, s28, v89
  v_xor_b32 v54, s29, v91
  v_or3_b32 v52, v52, v53, v54
  v_xor_b32 v53, s28, v93
  v_xor_b32 v54, s29, v95
  v_or3_b32 v52, v52, v53, v54
  s_branch L_skip6
L_stub6:
  s_setpc_b64 s[30:31]
L_skip6:
  v_cmp_ne_u32 vcc, 0, v52
  s_cbranch_vccz L_QC_ok
  s_cmp_gt_u32 s41, 32744
  s_cbranch_scc1 L_QC_ok_fast
  buffer_wbl2 sc1
  s_waitcnt vmcnt(0)
  s_sleep 16
L_QC_ok_fast:
  s_sub_u32 s41, s41, 1
  s_cbranch_scc0 L_QC_poll
L_QC_ok:
  v_add_f32 v64, v64, v68
  v_add_f32 v66, v66, v70
  v_add_f32 v64, v64, v72
  v_add_f32 v66, v66, v74
  v_add_f32 v64, v64, v76
  v_add_f32 v66, v66, v78
  v_add_f32 v64, v64, v80
  v_add_f32 v66, v66, v82
  v_add_f32 v64, v64, v84
  v_add_f32 v66, v66, v86
  v_add_f32 v64, v64, v88
  v_add_f32 v66, v66, v90
  v_add_f32 v64, v64, v92
  v_add_f32 v66, v66, v94
  v_cvt_pk_bf16_f32 v4, v64, v66
  v_lshl_add_u32 v5, v50, 2, v51
  v_lshlrev_b32 v5, 2, v5
  v_add_u32 v5, s27, v5
  ds_write_b32 v5, v4
  s_setpc_b64 s[30:31]
L_helper2:
  s_mov_b32 s34, 0xcccccccc
  s_mov_b32 s35, 0xcccccccc
  s_mov_b32 s36, 0xaaaaaaaa
  s_mov_b32 s37, 0xaaaaaaaa
  s_mov_b32 s38, 0x3db504f3
  s_mov_b32 s39, 0x3fb8aa3b
  s_mov_b32 s40, 0xffff0000
  s_mov_b32 s16, s88
  s_mov_b32 s17, s89
  s_mov_b32 s18, 536870912
  s_mov_b32 s19, 0x00020000
  s_mov_b32 s46, 0x05040100
  s_mov_b32 s47, 0x07060302
  v_lshlrev_b32 v2, 4, v1
  s_waitcnt lgkmcnt(0)
  s_add_u32 s32, s32, 1
  s_xor_b32 s28, s32, 0x5bd1e995
  s_mul_i32 s29, s32, 0x9e3779b1
  s_add_u32 s29, s29, s33
  s_bitcmp1_b32 s4, 0
  s_cbranch_scc1 L_h_qdone
  s_mov_b32 s43, 0
  s_waitcnt vmcnt(0)
L_h_qloop:
  v_mov_b32 v12, 0
  v_mov_b32 v13, 0
  v_mov_b32 v14, 0
  v_mov_b32 v15, 0
  v_mov_b32 v16, 0
  v_mov_b32 v17, 0
  v_mov_b32 v18, 0
  v_mov_b32 v19, 0
  s_call_b64 s[30:31], L_WS0
  s_call_b64 s[30:31], L_WS1
  s_call_b64 s[30:31], L_RED8
  s_lshr_b32 s25, s4, 1
  s_xor_b32 s25, s25, 1
  s_lshl_b32 s25, s25, 5
  s_add_u32 s25, s25, s7
  s_lshl_b32 s25, s25, 1
  s_add_u32 s25, s25, s43
  s_lshl_b32 s25, s25, 3
  s_add_u32 s25, s25, s10
  s_lshl_b32 s25, s25, 10
  s_add_u32 s25, s25, 1048576
  v_mov_b32 v44, v12
  v_mov_b32 v45, s28
  v_mov_b32 v46, v13
  v_mov_b32 v47, s29
  buffer_store_dwordx4 v[44:47], v2, s[16:19], s25 offen
L_h_nost:
  v_mov_b32 v32, v33
  s_add_u32 s43, s43, 1
  s_cmp_lt_u32 s43, 2
  s_cbranch_scc1 L_h_qloop
L_h_qdone:
L_h_A:
  s_lshr_b32 s25, s6, 4
  s_lshl_b32 s25, s25, 3
  s_add_u32 s25, s25, s5
  s_lshl_b32 s24, s25, 21
  s_and_b32 s25, s6, 15
  s_lshl_b32 s25, s25, 15
  s_add_u32 s24, s24, s25
  s_add_u32 s24, s24, 1572864
  s_mov_b32 s14, 0x2000000
  s_lshr_b32 s25, s2, 5
  s_xor_b32 s25, s25, s4
  s_and_b32 s25, s25, 3
  s_lshl_b32 s25, s25, 11
  v_lshlrev_b32 v208, 4, v1
  v_add_u32 v208, s25, v208
  v_add_u32 v209, 8192, v208
  v_add_u32 v210, 16384, v208
  v_add_u32 v211, 24576, v208
  s_mov_b32 s12, s66
  s_mov_b32 s13, s67
  s_mov_b32 s20, s68
  s_mov_b32 s21, s69
  s_mov_b32 s22, 0x2000000
  buffer_load_dwordx4 v[128:131], v208, s[12:15], s24 offen offset:0 nt
  buffer_load_dwordx4 v[132:135], v208, s[12:15], s24 offen offset:1024 nt
  buffer_load_dwordx4 v[136:139], v209, s[12:15], s24 offen offset:0 nt
  buffer_load_dwordx4 v[140:143], v209, s[12:15], s24 offen offset:1024 nt
  buffer_load_dwordx4 v[144:147], v210, s[12:15], s24 offen offset:0 nt
  buffer_load_dwordx4 v[148:151], v210, s[12:15], s24 offen offset:1024 nt
  buffer_load_dwordx4 v[152:155], v211, s[12:15], s24 offen offset:0 nt
  buffer_load_dwordx4 v[156:159], v211, s[12:15], s24 offen offset:1024 nt
  buffer_load_dwordx4 v[160:163], v208, s[20:23], s24 offen offset:0 nt
  buffer_load_dwordx4 v[164:167], v208, s[20:23], s24 offen offset:1024 nt
  buffer_load_dwordx4 v[168:171], v209, s[20:23], s24 offen offset:0 nt
  buffer_load_dwordx4 v[172:175], v209, s[20:23], s24 offen offset:1024 nt
  buffer_load_dwordx4 v[176:179], v210, s[20:23], s24 offen offset:0 nt
  buffer_load_dwordx4 v[180:183], v210, s[20:23], s24 offen offset:1024 nt
  buffer_load_dwordx4 v[184:187], v211, s[20:23], s24 offen offset:0 nt
  buffer_load_dwordx4 v[188:191], v211, s[20:23], s24 offen offset:1024 nt
  v_lshlrev_b32 v52, 13, v51
  v_lshl_add_u32 v52, v50, 3, v52
  v_add_u32 v53, 0x1000, v52
  s_mov_b32 s14, 0x400000
  s_lshl_b32 s26, s96, 2
  s_add_u32 s26, s26, s4
  s_lshl_b32 s26, s26, 15
  s_lshl_b32 s25, s10, 7
  s_add_u32 s26, s26, s25
  s_mov_b32 s12, s72
  s_mov_b32 s13, s73
  buffer_load_dwordx2 v[192:193], v52, s[12:15], s26 offen offset:0 nt
  buffer_load_dwordx2 v[194:195], v52, s[12:15], s26 offen offset:1024 nt
  buffer_load_dwordx2 v[196:197], v52, s[12:15], s26 offen offset:2048 nt
  buffer_load_dwordx2 v[198:199], v52, s[12:15], s26 offen offset:3072 nt
  buffer_load_dwordx2 v[200:201], v53, s[12:15], s26 offen offset:0 nt
  buffer_load_dwordx2 v[202:203], v53, s[12:15], s26 offen offset:1024 nt
  buffer_load_dwordx2 v[204:205], v53, s[12:15], s26 offen offset:2048 nt
  buffer_load_dwordx2 v[206:207], v53, s[12:15], s26 offen offset:3072 nt
  s_lshl_b32 s26, s97, 2
  s_add_u32 s26, s26, s4
  s_lshl_b32 s26, s26, 15
  s_lshl_b32 s25, s10, 7
  s_add_u32 s26, s26, s25
  s_mov_b32 s12, s82
  s_mov_b32 s13, s83
  buffer_load_dwordx2 v[224:225], v52, s[12:15], s26 offen offset:0 nt
  buffer_load_dwordx2 v[226:227], v52, s[12:15], s26 offen offset:1024 nt
  buffer_load_dwordx2 v[228:229], v52, s[12:15], s26 offen offset:2048 nt
  buffer_load_dwordx2 v[230:231], v52, s[12:15], s26 offen offset:3072 nt
  buffer_load_dwordx2 v[232:233], v53, s[12:15], s26 offen offset:0 nt
  buffer_load_dwordx2 v[234:235], v53, s[12:15], s26 offen offset:1024 nt
  buffer_load_dwordx2 v[236:237], v53, s[12:15], s26 offen offset:2048 nt
  buffer_load_dwordx2 v[238:239], v53, s[12:15], s26 offen offset:3072 nt
  s_cmp_eq_u32 s4, 1
  s_cbranch_scc0 L_h_A2
  s_add_u32 s26, s97, 32
  s_lshl_b32 s26, s26, 1
  s_add_u32 s26, s26, s8
  s_lshl_b32 s26, s26, 13
  s_mov_b32 s27, 0
  s_mov_b32 s42, 1
  s_call_b64 s[30:31], L_QC
  v_mov_b32 v52, 1296
  v_mov_b32 v53, 1
  ds_write_b32 v52, v53
L_h_A2:
  s_mov_b32 s42, 0
  s_lshl_b32 s45, s5, 2
  s_add_u32 s45, s45, s4
  s_lshl_b32 s45, s45, 1
  s_lshr_b32 s25, s6, 4
  s_add_u32 s45, s45, s25
  s_lshl_b32 s26, s45, 13
  s_lshl_b32 s27, s4, 8
  s_add_u32 s27, s27, 256
  s_call_b64 s[30:31], L_QC
  v_mov_b32 v52, 1280
  v_mov_b32 v53, 1
  s_mov_b64 exec, 1
  ds_add_u32 v52, v53
  s_mov_b64 exec, -1
  v_mov_b32 v52, 1280
  s_mov_b32 s41, 2097152
L_hs0:
  ds_read_b32 v53, v52
  s_branch L_skip7
L_stub7:
  s_setpc_b64 s[30:31]
L_skip7:
  s_waitcnt lgkmcnt(0)
  v_readfirstlane_b32 s25, v53
  s_nop 0
  s_cmp_ge_u32 s25, 4
  s_cbranch_scc1 L_hs0_ok
  s_sleep 1
  s_sub_u32 s41, s41, 1
  s_cbranch_scc0 L_hs0
L_hs0_ok:
  s_mov_b32 s43, 0
L_A_loop:
  s_lshl_b32 s25, s43, 8
  v_lshlrev_b32 v4, 4, v50
  v_add_u32 v4, s25, v4
  ds_read_b128 v[8:11], v4 offset:256
  s_waitcnt lgkmcnt(0)
  s_call_b64 s[30:31], L_KB2
  v_mov_b32 v37, v30
  v_mov_b32 v36, v30
  v_cvt_pk_bf16_f32 v4, v36, v37
  v_lshlrev_b32 v36, 16, v4
  v_and_b32 v37, s40, v4
  v_mul_f32 v36, s38, v36
  v_mul_f32 v37, s38, v37
  v_cvt_pk_bf16_f32 v4, v36, v37
  v_lshlrev_b32 v36, 16, v4
  v_and_b32 v37, s40, v4
  v_mov_b32 v48, v36
  s_nop 1
  v_max_f32_dpp v48, v48, v48 row_mirror row_mask:0xf bank_mask:0xf
  s_nop 1
  v_max_f32_dpp v48, v48, v48 row_half_mirror row_mask:0xf bank_mask:0xf
  s_nop 1
  v_max_f32_dpp v48, v48, v48 quad_perm:[2,3,0,1] row_mask:0xf bank_mask:0xf
  s_nop 1
  v_max_f32_dpp v48, v48, v48 quad_perm:[1,0,3,2] row_mask:0xf bank_mask:0xf
  v_mov_b32 v4, v48
  s_nop 1
  v_permlane16_swap_b32 v48, v4
  v_max_f32 v48, v48, v4
  v_mov_b32 v4, v48
  s_nop 1
  v_permlane32_swap_b32 v48, v4
  v_max_f32 v48, v48, v4
  v_sub_f32 v36, v36, v48
  v_mul_f32 v36, s39, v36
  v_exp_f32 v36, v36
  s_nop 0
  v_mul_f32 v49, 0.5, v36
  v_cvt_pk_bf16_f32 v33, v36, 0
  s_nop 0
  v_add_f32_dpp v49, v49, v49 row_mirror row_mask:0xf bank_mask:0xf
  s_nop 1
  v_add_f32_dpp v49, v49, v49 row_half_mirror row_mask:0xf bank_mask:0xf
  s_nop 1
  v_add_f32_dpp v49, v49, v49 quad_perm:[2,3,0,1] row_mask:0xf bank_mask:0xf
  s_nop 1
  v_add_f32_dpp v49, v49, v49 quad_perm:[1,0,3,2] row_mask:0xf bank_mask:0xf
  v_mov_b32 v4, v49
  s_nop 1
  v_permlane16_swap_b32 v49, v4
  v_add_f32 v49, v49, v4
  v_mov_b32 v4, v49
  s_nop 1
  v_permlane32_swap_b32 v49, v4
  v_add_f32 v49, v49, v4
  v_mov_b32 v12, 0
  v_mov_b32 v13, 0
  v_mov_b32 v14, 0
  v_mov_b32 v15, 0
  v_mov_b32 v16, 0
  v_mov_b32 v17, 0
  v_mov_b32 v18, 0
  v_mov_b32 v19, 0
  s_call_b64 s[30:31], L_WS3L
  s_call_b64 s[30:31], L_RED8
  s_lshl_b32 s25, s43, 2
  s_add_u32 s25, s25, s4
  s_lshl_b32 s26, s25, 9
  s_lshl_b32 s25, s25, 3
  v_lshlrev_b32 v4, 3, v1
  v_add_u32 v4, s26, v4
  v_mov_b32 v5, s25
  ds_write_b64 v4, v[12:13] offset:2048
  s_mov_b64 exec, 1
  ds_write_b64 v5, v[48:49] offset:1408
  s_mov_b64 exec, -1
  s_add_u32 s43, s43, 1
  s_cmp_lt_u32 s43, 4
  s_cbranch_scc1 L_A_loop
L_A_done:
  v_mov_b32 v52, 1284
  v_mov_b32 v53, 1
  s_mov_b64 exec, 1
  ds_add_u32 v52, v53
  s_mov_b64 exec, -1
  v_mov_b32 v52, 1284
  s_mov_b32 s41, 2097152
L_hs1:
  ds_read_b32 v53, v52
  s_waitcnt lgkmcnt(0)
  v_readfirstlane_b32 s25, v53
  s_nop 0
  s_cmp_ge_u32 s25, 4
  s_cbranch_scc1 L_hs1_ok
  s_sleep 1
  s_sub_u32 s41, s41, 1
  s_cbranch_scc0 L_hs1
L_hs1_ok:
  s_lshl_b32 s25, s4, 5
  v_mov_b32 v5, s25
  s_lshl_b32 s26, s4, 11
  v_lshlrev_b32 v4, 3, v1
  v_add_u32 v4, s26, v4
  ds_read_b128 v[64:67], v5 offset:1408
  ds_read_b128 v[68:71], v5 offset:1424
  ds_read_b64 v[72:73], v4 offset:2048
  ds_read_b64 v[74:75], v4 offset:2560
  ds_read_b64 v[76:77], v4 offset:3072
  ds_read_b64 v[78:79], v4 offset:3584
  s_waitcnt lgkmcnt(0)
  v_max3_f32 v48, v64, v66, v68
  v_max_f32 v48, v48, v70
  v_sub_f32 v64, v64, v48
  v_sub_f32 v66, v66, v48
  v_sub_f32 v68, v68, v48
  v_sub_f32 v70, v70, v48
  v_mul_f32 v64, s39, v64
  v_mul_f32 v66, s39, v66
  v_mul_f32 v68, s39, v68
  v_mul_f32 v70, s39, v70
  v_exp_f32 v64, v64
  v_exp_f32 v66, v66
  v_exp_f32 v68, v68
  v_exp_f32 v70, v70
  v_mul_f32 v49, v64, v65
  v_mul_f32 v12, v64, v72
  v_mul_f32 v13, v64, v73
  v_fmac_f32 v49, v66, v67
  v_fmac_f32 v12, v66, v74
  v_fmac_f32 v13, v66, v75
  v_fmac_f32 v49, v68, v69
  v_fmac_f32 v12, v68, v76
  v_fmac_f32 v13, v68, v77
  v_fmac_f32 v49, v70, v71
  v_fmac_f32 v12, v70, v78
  v_fmac_f32 v13, v70, v79
  s_lshl_b32 s44, s45, 4
  s_and_b32 s25, s6, 15
  s_add_u32 s44, s44, s25
  s_mul_i32 s44, s44, 640
  s_add_u32 s44, s44, 2097152
  s_mov_b32 s90, s44
  s_mov_b32 s91, 4
  s_call_b64 s[30:31], L_PUBPART
  s_call_b64 s[30:31], L_PUBML
L_FIN:
  s_cmp_eq_u32 s42, 0
  s_cselect_b32 s12, s72, s82
  s_cselect_b32 s13, s73, s83
  s_cselect_b32 s7, s96, s97
  s_mov_b32 s14, 0x400000
  v_lshlrev_b32 v2, 13, v51
  v_lshl_add_u32 v2, v50, 3, v2
  v_add_u32 v3, 0x1000, v2
  s_lshl_b32 s24, s7, 2
  s_add_u32 s24, s24, s4
  s_lshl_b32 s24, s24, 15
  s_lshl_b32 s25, s10, 7
  s_add_u32 s24, s24, s25
  s_lshl_b32 s45, s42, 5
  s_add_u32 s45, s45, s7
  s_mul_i32 s26, s45, 20480
  s_add_u32 s26, s26, 2097152
  v_and_b32 v6, 31, v1
  v_mul_u32_u24 v7, 640, v6
  s_mov_b32 s41, 32768
  s_cmp_eq_u32 s42, 0
  s_cbranch_scc0 L_F_addrB
  s_lshl_b32 s25, s4, 6
  s_add_u32 s92, s26, s25
  s_add_u32 s93, s92, 256
  s_add_u32 s94, s92, 10240
  s_add_u32 s95, s92, 10496
  v_lshrrev_b32 v34, 2, v1
  v_mul_u32_u24 v34, 640, v34
  v_and_b32 v4, 3, v1
  v_lshl_add_u32 v34, v4, 4, v34
  s_branch L_F_ml0
L_F_addrB:
  s_lshl_b32 s92, s7, 14
  s_lshl_b32 s25, s4, 8
  s_add_u32 s92, s92, s25
  s_add_u32 s92, s92, 3670016
  s_add_u32 s93, s92, 1024
  s_add_u32 s94, s92, 8192
  s_add_u32 s95, s92, 9216
  v_lshrrev_b32 v34, 2, v50
  v_lshlrev_b32 v34, 11, v34
  v_and_b32 v4, 3, v50
  v_lshl_add_u32 v34, v4, 4, v34
  v_lshl_add_u32 v34, v51, 6, v34
  s_waitcnt lgkmcnt(0)
  v_mov_b32 v192, v224
  v_mov_b32 v193, v225
  v_mov_b32 v194, v226
  v_mov_b32 v195, v227
  v_mov_b32 v196, v228
  v_mov_b32 v197, v229
  v_mov_b32 v198, v230
  v_mov_b32 v199, v231
  v_mov_b32 v200, v232
  v_mov_b32 v201, v233
  v_mov_b32 v202, v234
  v_mov_b32 v203, v235
  v_mov_b32 v204, v236
  v_mov_b32 v205, v237
  v_mov_b32 v206, v238
  v_mov_b32 v207, v239
  s_barrier
  s_cmp_eq_u32 s4, 0
  s_cbranch_scc0 L_F_ml0
  s_lshl_b32 s25, s5, 12
  s_add_u32 s25, s25, 16384
  v_and_b32 v52, 31, v1
  v_lshlrev_b32 v52, 7, v52
  v_add_u32 v53, 8192, v52
  v_add_u32 v52, s25, v52
  s_lshl_b32 s11, s6, 7
  s_add_u32 s11, s11, s25
  v_mov_b32 v46, s28
  v_mov_b32 v47, s29
  s_mov_b32 exec_hi, 0
  buffer_load_dword v44, v52, s[16:19], 0 offen nt
  v_lshlrev_b32 v53, 3, v1
  s_mov_b64 exec, 0xffff
  buffer_store_dwordx2 v[46:47], v53, s[16:19], s11 offen
  s_mov_b64 exec, -1
  s_waitcnt vmcnt(0)
  v_cmp_eq_u32 vcc, s28, v44
  s_nop 1
  s_bcnt1_i32_b32 s25, vcc_lo
  s_lshl_b32 s25, s25, 3
  s_min_u32 s25, s25, 255
  s_mov_b32 s11, 1412571392
  s_lshr_b32 s25, s25, 3
  s_and_b32 s25, s25, 28
  s_lshr_b32 s25, s11, s25
  s_and_b32 s25, s25, 15
  s_add_u32 s25, s25, 16
  s_lshl_b32 s11, s5, 2
  s_lshr_b32 s11, 270602240, s11
  s_and_b32 s11, s11, 15
  s_add_u32 s25, s25, s11
  v_mov_b32 v52, 1300
  v_mov_b32 v53, s25
  ds_write_b32 v52, v53
L_F_ml0:
  s_cmp_eq_u32 s4, 1
  s_cbranch_scc0 L_F_wwait
L_F_mlpoll:
  s_mov_b32 exec_hi, 0
  buffer_load_dwordx4 v[44:47], v7, s[16:19], s26 offen offset:512 nt
  s_waitcnt vmcnt(0)
  v_xor_b32 v53, s28, v45
  v_xor_b32 v54, s29, v47
  v_or_b32 v52, v53, v54
  v_cmp_ne_u32 vcc, 0, v52
  s_mov_b64 exec, -1
  s_cbranch_vccz L_F_mlok
  s_sleep 32
  s_cmp_gt_u32 s41, 32744
  s_cbranch_scc1 L_F_mlok_fast
  buffer_wbl2 sc1
  s_waitcnt vmcnt(0)
  s_sleep 16
L_F_mlok_fast:
  s_sub_u32 s41, s41, 1
  s_cbranch_scc0 L_F_mlpoll
L_F_mlok:
  v_mov_b32 v48, v44
  s_nop 1
  v_max_f32_dpp v48, v48, v48 row_mirror row_mask:0xf bank_mask:0xf
  s_nop 1
  v_max_f32_dpp v48, v48, v48 row_half_mirror row_mask:0xf bank_mask:0xf
  s_nop 1
  v_max_f32_dpp v48, v48, v48 quad_perm:[2,3,0,1] row_mask:0xf bank_mask:0xf
  s_nop 1
  v_max_f32_dpp v48, v48, v48 quad_perm:[1,0,3,2] row_mask:0xf bank_mask:0xf
  v_sub_f32 v44, v44, v48
  v_mul_f32 v44, s39, v44
  v_exp_f32 v44, v44
  s_nop 0
  v_mul_f32 v44, v44, v46
  v_mov_b32 v49, v44
  s_nop 1
  v_add_f32_dpp v49, v49, v49 row_mirror row_mask:0xf bank_mask:0xf
  s_nop 1
  v_add_f32_dpp v49, v49, v49 row_half_mirror row_mask:0xf bank_mask:0xf
  s_nop 1
  v_add_f32_dpp v49, v49, v49 quad_perm:[2,3,0,1] row_mask:0xf bank_mask:0xf
  s_nop 1
  v_add_f32_dpp v49, v49, v49 quad_perm:[1,0,3,2] row_mask:0xf bank_mask:0xf
  v_rcp_f32 v49, v49
  s_lshl_b32 s25, s42, 7
  v_lshl_add_u32 v4, v6, 2, s25
  v_mul_f32 v44, v44, v49
  s_mov_b32 exec_hi, 0
  ds_write_b32 v4, v44 offset:1536
  s_mov_b32 exec_hi, -1
  s_add_u32 s25, s42, 1
  v_mov_b32 v52, 1308
  v_mov_b32 v53, s25
  ds_write_b32 v52, v53
L_F_wwait:
  s_add_u32 s11, s42, 1
  v_mov_b32 v52, 1308
  s_mov_b32 s41, 2097152
L_F_ww:
  ds_read_b32 v53, v52
  s_waitcnt lgkmcnt(0)
  v_readfirstlane_b32 s25, v53
  s_nop 0
  s_cmp_ge_u32 s25, s11
  s_cbranch_scc1 L_F_ww_ok
  s_sleep 4
  s_sub_u32 s41, s41, 1
  s_cbranch_scc0 L_F_ww
L_F_ww_ok:
  s_waitcnt vmcnt(0)
  v_perm_b32 v208, v194, v192, s46
  v_perm_b32 v209, v202, v200, s46
  v_perm_b32 v210, v198, v196, s46
  v_perm_b32 v211, v206, v204, s46
  v_perm_b32 v212, v194, v192, s47
  v_perm_b32 v213, v202, v200, s47
  v_perm_b32 v214, v198, v196, s47
  v_perm_b32 v215, v206, v204, s47
  v_perm_b32 v216, v195, v193, s46
  v_perm_b32 v217, v203, v201, s46
  v_perm_b32 v218, v199, v197, s46
  v_perm_b32 v219, v207, v205, s46
  v_perm_b32 v220, v195, v193, s47
  v_perm_b32 v221, v203, v201, s47
  v_perm_b32 v222, v199, v197, s47
  v_perm_b32 v223, v207, v205, s47
  s_lshl_b32 s25, s42, 7
  v_lshl_add_u32 v5, v51, 4, s25
  ds_read_b128 v[56:59], v5 offset:1536
  ds_read_b128 v[60:63], v5 offset:1600
  s_lshl_b32 s25, s42, 2
  s_add_u32 s25, s25, s4
  s_lshl_b32 s25, s25, 9
  v_lshrrev_b32 v4, 1, v51
  v_lshlrev_b32 v4, 5, v4
  v_and_b32 v5, 1, v51
  v_lshl_add_u32 v5, v50, 1, v5
  v_add_lshl_u32 v4, v4, v5, 3
  v_add_u32 v4, s25, v4
  v_mov_b32 v35, v4
  s_mov_b32 s41, 32768
  v_mov_b32 v36, 1288
  v_mov_b32 v37, 1
  v_lshlrev_b32 v38, 3, v1
  v_lshlrev_b32 v39, 4, v1
  v_lshrrev_b32 v41, 5, v1
  v_lshlrev_b32 v40, 10, v6
  v_lshl_add_u32 v40, v41, 4, v40
  v_lshlrev_b32 v41, 2, v41
  v_bfe_u32 v42, v1, 3, 1
  v_lshl_add_u32 v41, v42, 10, v41
  v_bfe_u32 v42, v1, 2, 1
  v_lshl_add_u32 v41, v42, 1, v41
  v_mov_b32 v9, s28
  v_mov_b32 v11, s29
  s_add_u32 s98, s10, 8
  s_lshl_b32 s98, s98, 5
  s_add_u32 s98, s98, s96
  s_lshl_b32 s98, s98, 10
  s_add_u32 s98, s98, 65536
  s_lshl_b32 s99, s5, 15
  s_lshl_b32 s25, s6, 5
  s_add_u32 s99, s99, s25
  s_add_u32 s99, s99, 65536
  s_add_u32 s11, s99, 262144
  s_lshr_b32 s27, s6, 4
  s_lshl_b32 s27, s27, 11
  s_lshl_b32 s25, s5, 7
  s_add_u32 s27, s27, s25
  s_and_b32 s25, s6, 15
  s_lshl_b32 s25, s25, 3
  s_add_u32 s27, s27, s25
  s_mov_b32 s20, s84
  s_mov_b32 s21, s85
  s_mov_b32 s22, 4096
  s_mov_b32 s23, 0x00020000
  s_cmp_eq_u32 s42, 0
  s_cbranch_scc1 L_F_goA
  s_cmp_eq_u32 s4, 3
  s_cbranch_scc0 L_F_b2
  v_mov_b32 v52, 1304
  s_mov_b32 s41, 2097152
L_F_yaw:
  ds_read_b32 v53, v52
  s_waitcnt lgkmcnt(0)
  v_readfirstlane_b32 s25, v53
  s_nop 0
  s_cmp_ge_u32 s25, 1
  s_cbranch_scc1 L_F_yaw_ok
  s_sleep 4
  s_sub_u32 s41, s41, 1
  s_cbranch_scc0 L_F_yaw
L_F_yaw_ok:
  s_mov_b32 s42, 0
  s_call_b64 s[30:31], L_PUBY
  s_mov_b32 s42, 1
  s_mov_b32 s41, 32768
L_F_b2:
  s_barrier
L_F_go:
  s_mov_b64 vcc, -1
L_F_ppoll:
  s_mov_b64 exec, vcc
  buffer_load_dwordx4 v[64:67], v34, s[16:19], s92 offen nt
  buffer_load_dwordx4 v[68:71], v34, s[16:19], s93 offen nt
  buffer_load_dwordx4 v[72:75], v34, s[16:19], s94 offen nt
  buffer_load_dwordx4 v[76:79], v34, s[16:19], s95 offen nt
  s_mov_b64 exec, -1
L_F_pwait:
  s_waitcnt vmcnt(0)
  v_xor_b32 v53, s28, v65
  v_xor_b32 v54, s29, v67
  v_or_b32 v52, v53, v54
  v_xor_b32 v53, s28, v69
  v_xor_b32 v54, s29, v71
  v_or3_b32 v52, v52, v53, v54
  v_xor_b32 v53, s28, v73
  v_xor_b32 v54, s29, v75
  v_or3_b32 v52, v52, v53, v54
  v_xor_b32 v53, s28, v77
  v_xor_b32 v54, s29, v79
  v_or3_b32 v52, v52, v53, v54
  v_cmp_ne_u32 vcc, 0, v52
  s_cbranch_vccz L_F_pok
  s_cmp_gt_u32 s41, 32640
  s_cbranch_scc1 L_F_pok_fast
  buffer_wbl2 sc1
  s_waitcnt vmcnt(0)
  s_sleep 16
L_F_pok_fast:
  s_sub_u32 s41, s41, 1
  s_cbranch_scc0 L_F_ppoll
L_F_pok:
  v_mov_b32 v65, v68
  v_mov_b32 v67, v70
  v_mov_b32 v73, v76
  v_mov_b32 v75, v78
L_F_mm:
  s_waitcnt lgkmcnt(0)
  v_mfma_f32_16x16x32_bf16 v[96:99], v[64:67], v[208:211], 0
  v_mfma_f32_16x16x32_bf16 v[112:115], v[72:75], v[208:211], 0
  v_mfma_f32_16x16x32_bf16 v[100:103], v[64:67], v[212:215], 0
  v_mfma_f32_16x16x32_bf16 v[116:119], v[72:75], v[212:215], 0
  s_nop 4
  v_mul_f32 v12, v56, v96
  v_fmac_f32 v12, v57, v97
  v_fmac_f32 v12, v58, v98
  v_fmac_f32 v12, v59, v99
  v_mfma_f32_16x16x32_bf16 v[104:107], v[64:67], v[216:219], 0
  v_mul_f32 v16, v60, v112
  v_fmac_f32 v16, v61, v113
  v_fmac_f32 v16, v62, v114
  v_fmac_f32 v16, v63, v115
  v_mfma_f32_16x16x32_bf16 v[120:123], v[72:75], v[216:219], 0
  v_mul_f32 v13, v56, v100
  v_fmac_f32 v13, v57, v101
  v_fmac_f32 v13, v58, v102
  v_fmac_f32 v13, v59, v103
  v_mfma_f32_16x16x32_bf16 v[108:111], v[64:67], v[220:223], 0
  v_mul_f32 v17, v60, v116
  v_fmac_f32 v17, v61, v117
  v_fmac_f32 v17, v62, v118
  v_fmac_f32 v17, v63, v119
  v_mfma_f32_16x16x32_bf16 v[124:127], v[72:75], v[220:223], 0
  v_mul_f32 v14, v56, v104
  v_fmac_f32 v14, v57, v105
  v_fmac_f32 v14, v58, v106
  v_fmac_f32 v14, v59, v107
  v_mul_f32 v18, v60, v120
  v_fmac_f32 v18, v61, v121
  v_fmac_f32 v18, v62, v122
  v_fmac_f32 v18, v63, v123
  v_mul_f32 v15, v56, v108
  v_fmac_f32 v15, v57, v109
  v_fmac_f32 v15, v58, v110
  v_fmac_f32 v15, v59, v111
  v_mul_f32 v19, v60, v124
  v_fmac_f32 v19, v61, v125
  v_fmac_f32 v19, v62, v126
  v_fmac_f32 v19, v63, v127
  v_permlane32_swap_b32 v12, v16
  v_permlane32_swap_b32 v13, v17
  v_permlane32_swap_b32 v14, v18
  v_permlane32_swap_b32 v15, v19
  v_add_f32 v12, v12, v16
  v_add_f32 v13, v13, v17
  v_add_f32 v14, v14, v18
  v_add_f32 v15, v15, v19
  s_nop 0
  v_permlane16_swap_b32 v12, v14
  v_permlane16_swap_b32 v13, v15
  v_add_f32 v12, v12, v14
  v_add_f32 v13, v13, v15
  ds_write_b64 v35, v[12:13] offset:10240
  s_cmp_eq_u32 s42, 0
  s_mov_b32 s42, 1
  s_cbranch_scc1 L_FIN
  s_mov_b64 exec, 1
  ds_add_rtn_u32 v54, v36, v37
  s_mov_b64 exec, -1
  ds_read_b64 v[20:21], v38 offset:12288
  ds_read_b64 v[22:23], v38 offset:12800
  ds_read_b64 v[24:25], v38 offset:13312
  ds_read_b64 v[26:27], v38 offset:13824
  s_mov_b32 s41, 32768
  s_mov_b64 vcc, -1
  s_waitcnt lgkmcnt(0)
  v_readfirstlane_b32 s25, v54
  v_add_f32 v8, v20, v22
  v_add_f32 v10, v21, v23
  v_add_f32 v24, v24, v26
  v_add_f32 v25, v25, v27
  s_cmp_eq_u32 s25, 3
  s_cbranch_scc0 L_F_nl
  v_add_f32 v8, v8, v24
  v_add_f32 v10, v10, v25
  buffer_store_dwordx4 v[8:11], v39, s[16:19], s98 offen sc1
  s_branch L_exit
L_F_nl:
  s_cmp_eq_u32 s25, 0
  s_cbranch_scc0 L_exit
L_F_ypoll:
  s_mov_b64 exec, vcc
  buffer_load_dwordx4 v[68:71], v40, s[16:19], s11 offen sc1
  buffer_load_dwordx4 v[64:67], v40, s[16:19], s99 offen sc1
  s_mov_b64 exec, -1
  s_waitcnt vmcnt(0)
  v_xor_b32 v53, s28, v65
  v_xor_b32 v54, s29, v67
  v_or_b32 v52, v53, v54
  v_xor_b32 v53, s28, v69
  v_xor_b32 v54, s29, v71
  v_or3_b32 v52, v52, v53, v54
  v_cmp_ne_u32 vcc, 0, v52
  s_cbranch_vccz L_F_yok
  s_cmp_gt_u32 s41, 32640
  s_cbranch_scc1 L_F_yok_fast
  buffer_wbl2 sc1
  s_waitcnt vmcnt(0)
  s_sleep 16
L_F_yok_fast:
  s_sub_u32 s41, s41, 1
  s_cbranch_scc0 L_F_ypoll
L_F_yok:
  v_add_f32_dpp v64, v64, v64 row_mirror row_mask:0xf bank_mask:0x3
  v_add_f32_dpp v66, v66, v66 row_mirror row_mask:0xf bank_mask:0x3
  s_nop 0
  v_add_f32_dpp v64, v68, v68 row_mirror row_mask:0xf bank_mask:0xc
  v_add_f32_dpp v66, v70, v70 row_mirror row_mask:0xf bank_mask:0xc
  s_nop 0
  v_add_f32_dpp v64, v64, v64 row_half_mirror row_mask:0xf bank_mask:0x5
  s_nop 1
  v_add_f32_dpp v64, v66, v66 row_half_mirror row_mask:0xf bank_mask:0xa
  s_nop 1
  v_add_f32_dpp v64, v64, v64 quad_perm:[2,3,0,1] row_mask:0xf bank_mask:0xf
  s_nop 1
  v_add_f32_dpp v64, v64, v64 quad_perm:[1,0,3,2] row_mask:0xf bank_mask:0xf
  v_mov_b32 v65, v64
  s_nop 1
  v_permlane16_swap_b32 v64, v65
  v_add_f32 v64, v64, v65
  v_cvt_pk_bf16_f32 v64, v64, v64
  s_mov_b32 exec_lo, 0x1111
  s_mov_b32 exec_hi, 0x1111
  buffer_store_short v64, v41, s[20:23], s27 offen
  s_mov_b64 exec, -1
  s_nop 0
  s_cmp_eq_u32 s2, 0
  s_cbranch_scc0 L_exit
  v_mov_b32 v4, 0
  v_mov_b32 v5, s32
  s_mov_b64 exec, 1
  buffer_store_dword v5, v4, s[16:19], 0 offen sc1
  s_mov_b64 exec, -1
  s_branch L_exit
L_F_goA:
  buffer_load_dwordx4 v[64:67], v34, s[16:19], s92 offen nt
  s_waitcnt vmcnt(0)
  buffer_load_dwordx4 v[68:71], v34, s[16:19], s93 offen nt
  s_waitcnt vmcnt(0)
  buffer_load_dwordx4 v[72:75], v34, s[16:19], s94 offen nt
  s_waitcnt vmcnt(0)
  buffer_load_dwordx4 v[76:79], v34, s[16:19], s95 offen nt
  s_waitcnt vmcnt(0)
  s_waitcnt vmcnt(0)
  v_xor_b32 v53, s28, v65
  v_xor_b32 v54, s29, v67
  v_or_b32 v52, v53, v54
  v_xor_b32 v53, s28, v69
  v_xor_b32 v54, s29, v71
  v_or3_b32 v52, v52, v53, v54
  v_xor_b32 v53, s28, v73
  v_xor_b32 v54, s29, v75
  v_or3_b32 v52, v52, v53, v54
  v_xor_b32 v53, s28, v77
  v_xor_b32 v54, s29, v79
  v_or3_b32 v52, v52, v53, v54
  v_cmp_ne_u32 vcc, 0, v52
  s_cbranch_vccz L_F_okA
  s_sleep 32
  s_cmp_gt_u32 s41, 32744
  s_cbranch_scc1 L_F_okA_fast
  buffer_wbl2 sc1
  s_waitcnt vmcnt(0)
  s_sleep 16
L_F_okA_fast:
  s_sub_u32 s41, s41, 1
  s_cbranch_scc0 L_F_goA
L_F_okA:
  v_lshl_add_u32 v4, v50, 2, v51
  v_lshlrev_b32 v4, 2, v4
  ds_bpermute_b32 v65, v4, v68
  ds_bpermute_b32 v67, v4, v70
  ds_bpermute_b32 v64, v4, v64
  ds_bpermute_b32 v66, v4, v66
  ds_bpermute_b32 v73, v4, v76
  ds_bpermute_b32 v75, v4, v78
  ds_bpermute_b32 v72, v4, v72
  ds_bpermute_b32 v74, v4, v74
  s_branch L_F_mm
L_exit:
L_end:
  s_endpgm
.section .rodata,"a"
.p2align 6
.amdhsa_kernel concat_heads__sliding_block_cached__mha_block_cached__decode_kernel
  .amdhsa_next_free_vgpr 240
  .amdhsa_next_free_sgpr 102
  .amdhsa_accum_offset 240
  .amdhsa_group_segment_fixed_size 0
  .amdhsa_kernarg_size 104
  .amdhsa_user_sgpr_count 2
  .amdhsa_user_sgpr_kernarg_segment_ptr 1
  .amdhsa_system_sgpr_workgroup_id_x 1
  .amdhsa_float_denorm_mode_32 3
.end_amdhsa_kernel
```
